```python
import torch

def _softmax(x, axis=-1):
    return torch.softmax(x, dim=axis)
def _gelu(x):
    return torch.nn.functional.gelu(x, approximate="tanh")
def _silu(x):
    return torch.nn.functional.silu(x)
def _sigmoid(x):
    return torch.sigmoid(x)
def _layernorm(x, axis=-1, eps=1e-5):
    m = x.mean(dim=axis, keepdim=True)
    v = x.var(dim=axis, keepdim=True, unbiased=False)
    return (x - m) / torch.sqrt(v + eps)
def _scatter_add(tgt, idx, src, axis=0):
    return tgt.clone().index_add_(axis, idx, src)
def _segment_sum(src, seg, n):
    out = torch.zeros((n,) + src.shape[1:], dtype=src.dtype)
    return out.index_add_(0, seg, src)
def _pad(x, pw):
    flat = tuple(v for pair in reversed(pw) for v in pair)
    return torch.nn.functional.pad(x, flat)

kernel_name = 'gated_mix__gqa_block_cached__geglu_ffn__decode'

def setup_inputs():

    _w = (lambda a: (lambda t: t.to(torch.bfloat16) if t.is_floating_point() else t)(torch.as_tensor(a)))
    def _A_setup():
        B, Sq, D = 2, 1, 576
        Hq, Hkv, Sk, Dh = 32, 16, 32768, 128
        assert Hq % Hkv == 0, (Hq, Hkv)
        return {
            "x": _w((lambda *s: torch.randn(*s, dtype=torch.bfloat16) * 0.05)(B, Sq, D)),
            "k_cache": _w((lambda *s: torch.randn(*s, dtype=torch.bfloat16) * 6.4)(B, Hkv, Sk, Dh)),
            "v_cache": _w((lambda *s: torch.randn(*s, dtype=torch.bfloat16) * 0.4)(B, Hkv, Sk, Dh)),
            "wq": _w((lambda *s: torch.randn(*s, dtype=torch.bfloat16) * 6.4)(D, Hq * Dh) * (D ** -0.5)),
            "wo": _w((lambda *s: torch.randn(*s, dtype=torch.bfloat16) * 0.4)(Hq * Dh, D) * ((Hq * Dh) ** -0.5)),
        }
    _A_in = _A_setup()

    def _B_setup():
        B, S, D, F = 2, 1, 576, 4608
        return {
            "x": _w((lambda *s: torch.randn(*s, dtype=torch.bfloat16) * 0.05)(B, S, D)),
            "w_gate": _w((lambda *s: torch.randn(*s, dtype=torch.bfloat16) * 0.05)(D, F)),
            "w_up": _w((lambda *s: torch.randn(*s, dtype=torch.bfloat16) * 0.05)(D, F)),
            "w_down": _w((lambda *s: torch.randn(*s, dtype=torch.bfloat16) * 0.05)(F, D)),
        }
    _B_in = _B_setup()

    return {
        "A_x": _A_in["x"],
        "A_k_cache": _A_in["k_cache"],
        "A_v_cache": _A_in["v_cache"],
        "A_wq": _A_in["wq"],
        "A_wo": _A_in["wo"],
        "B_x": _B_in["x"],
        "B_w_gate": _B_in["w_gate"],
        "B_w_up": _B_in["w_up"],
        "B_w_down": _B_in["w_down"],
        "gate_w": _w((lambda *s: torch.randn(*s, dtype=torch.bfloat16) * 0.05)(576) * 16.0),
    }

def reference(A_x, A_k_cache, A_v_cache, A_wq, A_wo, B_x, B_w_gate, B_w_up, B_w_down, gate_w):
    def _A_ref(x, k_cache, v_cache, wq, wo):
        B, Sq, D = x.shape
        Hq, Dh = 32, 128
        Hkv = k_cache.shape[1]
        rep = Hq // Hkv
        q = (lambda x, *d: x.permute(*d))((x @ wq).reshape(B, Sq, Hq, Dh), 0, 2, 1, 3)
        k = (lambda x, n, axis: torch.repeat_interleave(x, n, dim=axis))(k_cache, rep, axis=1)
        v = (lambda x, n, axis: torch.repeat_interleave(x, n, dim=axis))(v_cache, rep, axis=1)
        scores = torch.einsum("bhqd,bhkd->bhqk", q, k) * (Dh ** -0.5)
        p = _softmax(scores, axis=-1)
        o = torch.einsum("bhqk,bhkd->bhqd", p, v)
        return (lambda x, *d: x.permute(*d))(o, 0, 2, 1, 3).reshape(B, Sq, Hq * Dh) @ wo

    def _B_ref(x, w_gate, w_up, w_down):
        return (_gelu(x @ w_gate) * (x @ w_up)) @ w_down

    x = A_x
    g = _sigmoid((x * gate_w).sum(-1, keepdims=True))
    a = _A_ref(x, A_k_cache, A_v_cache, A_wq, A_wo)
    b = _B_ref(x, B_w_gate, B_w_up, B_w_down)
    return g * a + (1 - g) * b
```

```asm
; @launch grid=(256,1,1) block=(512,1,1) lds=28672
.amdgcn_target "amdgcn-amd-amdhsa--gfx950"
.text
.globl gated_mix__gqa_block_cached__geglu_ffn__decode_kernel
.p2align 8
.type gated_mix__gqa_block_cached__geglu_ffn__decode_kernel,@function
gated_mix__gqa_block_cached__geglu_ffn__decode_kernel:
s_cmp_ge_u32 s2, 256
s_cbranch_scc1 L_end
s_load_dwordx16 s[36:51], s[0:1], 0
s_load_dwordx8 s[52:59], s[0:1], 64
s_load_dwordx2 s[60:61], s[0:1], 96
s_lshr_b32 s15, s2, 3
s_and_b32 s14, s2, 7
s_and_b32 s12, s15, 15
s_lshr_b32 s13, s15, 4
v_and_b32 v1, 63, v0
v_lshrrev_b32 v2, 6, v0
v_and_b32 v3, 15, v1
v_lshrrev_b32 v4, 4, v1
v_readfirstlane_b32 s18, v2
s_nop 3
s_cmp_ge_u32 s18, 4
s_cbranch_scc1 L_aux
s_mov_b32 s16, 0
s_mov_b32 s17, 232
s_cmp_eq_u32 s14, 1
s_cselect_b32 s16, 232, s16
s_cselect_b32 s17, 232, s17
s_cmp_eq_u32 s14, 2
s_cselect_b32 s16, 464, s16
s_cselect_b32 s17, 232, s17
s_cmp_eq_u32 s14, 3
s_cselect_b32 s16, 696, s16
s_cselect_b32 s17, 232, s17
s_cmp_eq_u32 s14, 4
s_cselect_b32 s16, 928, s16
s_cselect_b32 s17, 232, s17
s_cmp_eq_u32 s14, 5
s_cselect_b32 s16, 1160, s16
s_cselect_b32 s17, 232, s17
s_cmp_eq_u32 s14, 6
s_cselect_b32 s16, 1392, s16
s_cselect_b32 s17, 232, s17
s_cmp_eq_u32 s14, 7
s_cselect_b32 s16, 1624, s16
s_cselect_b32 s17, 168, s17
s_lshl_b32 s19, s15, 23
s_lshr_b32 s35, s17, 2
s_add_u32 s16, s16, s18
s_lshl_b32 s32, s16, 12
v_and_b32 v5, 3, v3
v_lshlrev_b32 v5, 10, v5
v_lshrrev_b32 v6, 2, v3
v_lshlrev_b32 v6, 8, v6
v_add_u32 v5, v5, v6
v_lshlrev_b32 v6, 4, v4
v_add_u32 v5, v5, v6
v_lshlrev_b32 v6, 4, v1
s_waitcnt lgkmcnt(0)
s_load_dword s62, s[60:61], 0x0
s_add_u32 s20, s38, s19
s_addc_u32 s21, s39, 0
s_mov_b32 s22, 0x800000
s_mov_b32 s23, 0x20000
s_add_u32 s24, s40, s19
s_addc_u32 s25, s41, 0
s_mov_b32 s26, 0x800000
s_mov_b32 s27, 0x20000
s_mov_b32 s72, s60
s_mov_b32 s73, s61
s_mov_b32 s74, 10485760
s_mov_b32 s75, 0x20000
s_lshl_b32 s28, s15, 8
s_add_u32 s28, s28, 6815744
s_barrier
buffer_load_dwordx4 v[64:67], v5, s[20:23], s32 offen offset:0 nt
buffer_load_dwordx4 v[68:71], v5, s[20:23], s32 offen offset:64 nt
buffer_load_dwordx4 v[72:75], v5, s[20:23], s32 offen offset:128 nt
buffer_load_dwordx4 v[76:79], v5, s[20:23], s32 offen offset:192 nt
buffer_load_dwordx4 v[80:83], v6, s[24:27], s32 offen offset:0 nt
buffer_load_dwordx4 v[84:87], v6, s[24:27], s32 offen offset:1024 nt
buffer_load_dwordx4 v[88:91], v6, s[24:27], s32 offen offset:2048 nt
buffer_load_dwordx4 v[92:95], v6, s[24:27], s32 offen offset:3072 nt
s_add_u32 s32, s32, 16384
v_and_b32 v7, 1, v1
v_cmp_eq_u32 vcc, 1, v7
v_mov_b32 v8, 0x0c0c0100
v_mov_b32 v9, 0x01000c0c
v_cndmask_b32 v8, v8, v9, vcc
v_mov_b32 v9, 0x0c0c0302
v_mov_b32 v10, 0x03020c0c
v_cndmask_b32 v9, v9, v10, vcc
v_bfe_u32 v7, v1, 1, 2
v_mov_b32 v10, 0x0c0c0c0c
v_cmp_eq_u32 vcc, 0, v7
s_nop 1
v_cndmask_b32 v16, v10, v8, vcc
v_cndmask_b32 v20, v10, v9, vcc
v_cmp_eq_u32 vcc, 1, v7
s_nop 1
v_cndmask_b32 v17, v10, v8, vcc
v_cndmask_b32 v21, v10, v9, vcc
v_cmp_eq_u32 vcc, 2, v7
s_nop 1
v_cndmask_b32 v18, v10, v8, vcc
v_cndmask_b32 v22, v10, v9, vcc
v_cmp_eq_u32 vcc, 3, v7
s_nop 1
v_cndmask_b32 v19, v10, v8, vcc
v_cndmask_b32 v23, v10, v9, vcc
buffer_load_dwordx4 v[96:99], v5, s[20:23], s32 offen offset:0 nt
buffer_load_dwordx4 v[100:103], v5, s[20:23], s32 offen offset:64 nt
buffer_load_dwordx4 v[104:107], v5, s[20:23], s32 offen offset:128 nt
buffer_load_dwordx4 v[108:111], v5, s[20:23], s32 offen offset:192 nt
buffer_load_dwordx4 v[112:115], v6, s[24:27], s32 offen offset:0 nt
buffer_load_dwordx4 v[116:119], v6, s[24:27], s32 offen offset:1024 nt
buffer_load_dwordx4 v[120:123], v6, s[24:27], s32 offen offset:2048 nt
buffer_load_dwordx4 v[124:127], v6, s[24:27], s32 offen offset:3072 nt
s_add_u32 s32, s32, 16384
v_mov_b32 v40, 0xf149f2ca
v_mov_b32 v41, 0
v_mov_b32 v44, 0
v_mov_b32 v45, 0
v_mov_b32 v46, 0
v_mov_b32 v47, 0
s_mov_b32 s34, 0x3fb8aa3b
s_mov_b32 s33, 0x3db504f3
v_lshrrev_b32 v11, 3, v3
v_lshlrev_b32 v11, 8, v11
v_lshlrev_b32 v12, 4, v4
v_add_u32 v11, v11, v12
v_mov_b32 v2, 0
s_waitcnt lgkmcnt(0)
s_add_u32 s62, s62, 1
s_barrier
ds_read_b128 v[24:27], v11 offset:0
ds_read_b128 v[28:31], v11 offset:64
ds_read_b128 v[32:35], v11 offset:128
ds_read_b128 v[36:39], v11 offset:192
s_waitcnt lgkmcnt(0)
s_waitcnt vmcnt(12)
v_mfma_f32_16x16x32_bf16 v[48:51], v[64:67], v[24:27], 0
v_mfma_f32_16x16x32_bf16 v[48:51], v[68:71], v[28:31], v[48:51]
v_mfma_f32_16x16x32_bf16 v[48:51], v[72:75], v[32:35], v[48:51]
v_mfma_f32_16x16x32_bf16 v[48:51], v[76:79], v[36:39], v[48:51]
buffer_load_dwordx4 v[64:67], v5, s[20:23], s32 offen offset:0 nt
buffer_load_dwordx4 v[68:71], v5, s[20:23], s32 offen offset:64 nt
buffer_load_dwordx4 v[72:75], v5, s[20:23], s32 offen offset:128 nt
buffer_load_dwordx4 v[76:79], v5, s[20:23], s32 offen offset:192 nt
s_nop 3
v_cvt_pk_bf16_f32 v52, v48, v49
v_cvt_pk_bf16_f32 v53, v50, v51
v_lshlrev_b32 v48, 16, v52
v_and_b32 v49, 0xffff0000, v52
v_lshlrev_b32 v50, 16, v53
v_and_b32 v51, 0xffff0000, v53
v_mul_f32 v48, s33, v48
v_mul_f32 v49, s33, v49
v_mul_f32 v50, s33, v50
v_mul_f32 v51, s33, v51
v_cvt_pk_bf16_f32 v52, v48, v49
v_cvt_pk_bf16_f32 v53, v50, v51
v_lshlrev_b32 v48, 16, v52
v_and_b32 v49, 0xffff0000, v52
v_lshlrev_b32 v50, 16, v53
v_and_b32 v51, 0xffff0000, v53
v_max3_f32 v52, v48, v49, v50
v_max_f32 v52, v52, v51
v_mov_b32 v53, v52
s_nop 1
v_permlane32_swap_b32 v52, v53
v_max_f32 v52, v52, v53
v_mov_b32 v53, v52
s_nop 1
v_permlane16_swap_b32 v52, v53
v_max3_f32 v52, v52, v53, v40
v_sub_f32 v53, v40, v52
v_mul_f32 v53, s34, v53
v_exp_f32 v53, v53
v_mov_b32 v40, v52
v_mul_f32 v54, s34, v52
v_fma_f32 v48, v48, s34, -v54
v_fma_f32 v49, v49, s34, -v54
v_fma_f32 v50, v50, s34, -v54
v_fma_f32 v51, v51, s34, -v54
v_exp_f32 v48, v48
v_exp_f32 v49, v49
v_exp_f32 v50, v50
v_exp_f32 v51, v51
v_mul_f32 v44, v44, v53
v_mul_f32 v45, v45, v53
v_mul_f32 v46, v46, v53
v_mul_f32 v47, v47, v53
v_fma_f32 v41, v41, v53, v48
v_add_f32 v55, v49, v50
v_add_f32 v41, v41, v51
v_add_f32 v41, v41, v55
v_cvt_pk_bf16_f32 v56, v48, v49
v_cvt_pk_bf16_f32 v57, v50, v51
s_waitcnt vmcnt(12)
v_perm_b32 v8, v56, v56, v16
v_perm_b32 v9, v56, v56, v17
v_perm_b32 v10, v56, v56, v18
v_perm_b32 v11, v56, v56, v19
s_nop 1
v_mfma_f32_16x16x32_bf16 v[44:47], v[80:83], v[8:11], v[44:47]
v_perm_b32 v12, v56, v56, v20
v_perm_b32 v13, v56, v56, v21
v_perm_b32 v14, v56, v56, v22
v_perm_b32 v15, v56, v56, v23
s_nop 1
v_mfma_f32_16x16x32_bf16 v[44:47], v[84:87], v[12:15], v[44:47]
v_perm_b32 v8, v57, v57, v16
v_perm_b32 v9, v57, v57, v17
v_perm_b32 v10, v57, v57, v18
v_perm_b32 v11, v57, v57, v19
s_nop 1
v_mfma_f32_16x16x32_bf16 v[44:47], v[88:91], v[8:11], v[44:47]
v_perm_b32 v12, v57, v57, v20
v_perm_b32 v13, v57, v57, v21
v_perm_b32 v14, v57, v57, v22
v_perm_b32 v15, v57, v57, v23
s_nop 1
v_mfma_f32_16x16x32_bf16 v[44:47], v[92:95], v[12:15], v[44:47]
buffer_load_dwordx4 v[80:83], v6, s[24:27], s32 offen offset:0 nt
buffer_load_dwordx4 v[84:87], v6, s[24:27], s32 offen offset:1024 nt
buffer_load_dwordx4 v[88:91], v6, s[24:27], s32 offen offset:2048 nt
buffer_load_dwordx4 v[92:95], v6, s[24:27], s32 offen offset:3072 nt
s_add_u32 s32, s32, 16384
s_waitcnt vmcnt(12)
v_mfma_f32_16x16x32_bf16 v[48:51], v[96:99], v[24:27], 0
v_mfma_f32_16x16x32_bf16 v[48:51], v[100:103], v[28:31], v[48:51]
v_mfma_f32_16x16x32_bf16 v[48:51], v[104:107], v[32:35], v[48:51]
v_mfma_f32_16x16x32_bf16 v[48:51], v[108:111], v[36:39], v[48:51]
buffer_load_dwordx4 v[96:99], v5, s[20:23], s32 offen offset:0 nt
buffer_load_dwordx4 v[100:103], v5, s[20:23], s32 offen offset:64 nt
buffer_load_dwordx4 v[104:107], v5, s[20:23], s32 offen offset:128 nt
buffer_load_dwordx4 v[108:111], v5, s[20:23], s32 offen offset:192 nt
s_nop 3
v_cvt_pk_bf16_f32 v52, v48, v49
v_cvt_pk_bf16_f32 v53, v50, v51
v_lshlrev_b32 v48, 16, v52
v_and_b32 v49, 0xffff0000, v52
v_lshlrev_b32 v50, 16, v53
v_and_b32 v51, 0xffff0000, v53
v_mul_f32 v48, s33, v48
v_mul_f32 v49, s33, v49
v_mul_f32 v50, s33, v50
v_mul_f32 v51, s33, v51
v_cvt_pk_bf16_f32 v52, v48, v49
v_cvt_pk_bf16_f32 v53, v50, v51
v_lshlrev_b32 v48, 16, v52
v_and_b32 v49, 0xffff0000, v52
v_lshlrev_b32 v50, 16, v53
v_and_b32 v51, 0xffff0000, v53
v_max3_f32 v52, v48, v49, v50
v_max_f32 v52, v52, v51
v_mov_b32 v53, v52
s_nop 1
v_permlane32_swap_b32 v52, v53
v_max_f32 v52, v52, v53
v_mov_b32 v53, v52
s_nop 1
v_permlane16_swap_b32 v52, v53
v_max3_f32 v52, v52, v53, v40
v_sub_f32 v53, v40, v52
v_mul_f32 v53, s34, v53
v_exp_f32 v53, v53
v_mov_b32 v40, v52
v_mul_f32 v54, s34, v52
v_fma_f32 v48, v48, s34, -v54
v_fma_f32 v49, v49, s34, -v54
v_fma_f32 v50, v50, s34, -v54
v_fma_f32 v51, v51, s34, -v54
v_exp_f32 v48, v48
v_exp_f32 v49, v49
v_exp_f32 v50, v50
v_exp_f32 v51, v51
v_mul_f32 v44, v44, v53
v_mul_f32 v45, v45, v53
v_mul_f32 v46, v46, v53
v_mul_f32 v47, v47, v53
v_fma_f32 v41, v41, v53, v48
v_add_f32 v55, v49, v50
v_add_f32 v41, v41, v51
v_add_f32 v41, v41, v55
v_cvt_pk_bf16_f32 v56, v48, v49
v_cvt_pk_bf16_f32 v57, v50, v51
s_waitcnt vmcnt(12)
v_perm_b32 v8, v56, v56, v16
v_perm_b32 v9, v56, v56, v17
v_perm_b32 v10, v56, v56, v18
v_perm_b32 v11, v56, v56, v19
s_nop 1
v_mfma_f32_16x16x32_bf16 v[44:47], v[112:115], v[8:11], v[44:47]
v_perm_b32 v12, v56, v56, v20
v_perm_b32 v13, v56, v56, v21
v_perm_b32 v14, v56, v56, v22
v_perm_b32 v15, v56, v56, v23
s_nop 1
v_mfma_f32_16x16x32_bf16 v[44:47], v[116:119], v[12:15], v[44:47]
v_perm_b32 v8, v57, v57, v16
v_perm_b32 v9, v57, v57, v17
v_perm_b32 v10, v57, v57, v18
v_perm_b32 v11, v57, v57, v19
s_nop 1
v_mfma_f32_16x16x32_bf16 v[44:47], v[120:123], v[8:11], v[44:47]
v_perm_b32 v12, v57, v57, v20
v_perm_b32 v13, v57, v57, v21
v_perm_b32 v14, v57, v57, v22
v_perm_b32 v15, v57, v57, v23
s_nop 1
v_mfma_f32_16x16x32_bf16 v[44:47], v[124:127], v[12:15], v[44:47]
buffer_load_dwordx4 v[112:115], v6, s[24:27], s32 offen offset:0 nt
buffer_load_dwordx4 v[116:119], v6, s[24:27], s32 offen offset:1024 nt
buffer_load_dwordx4 v[120:123], v6, s[24:27], s32 offen offset:2048 nt
buffer_load_dwordx4 v[124:127], v6, s[24:27], s32 offen offset:3072 nt
s_add_u32 s32, s32, 16384
s_sub_u32 s35, s35, 6
s_lshr_b32 s35, s35, 1
L_loop:
s_waitcnt vmcnt(12)
v_mfma_f32_16x16x32_bf16 v[48:51], v[64:67], v[24:27], 0
v_mfma_f32_16x16x32_bf16 v[48:51], v[68:71], v[28:31], v[48:51]
v_mfma_f32_16x16x32_bf16 v[48:51], v[72:75], v[32:35], v[48:51]
v_mfma_f32_16x16x32_bf16 v[48:51], v[76:79], v[36:39], v[48:51]
buffer_load_dwordx4 v[64:67], v5, s[20:23], s32 offen offset:0 nt
buffer_load_dwordx4 v[68:71], v5, s[20:23], s32 offen offset:64 nt
buffer_load_dwordx4 v[72:75], v5, s[20:23], s32 offen offset:128 nt
buffer_load_dwordx4 v[76:79], v5, s[20:23], s32 offen offset:192 nt
s_nop 3
v_cvt_pk_bf16_f32 v52, v48, v49
v_cvt_pk_bf16_f32 v53, v50, v51
v_lshlrev_b32 v48, 16, v52
v_and_b32 v49, 0xffff0000, v52
v_lshlrev_b32 v50, 16, v53
v_and_b32 v51, 0xffff0000, v53
v_mul_f32 v48, s33, v48
v_mul_f32 v49, s33, v49
v_mul_f32 v50, s33, v50
v_mul_f32 v51, s33, v51
v_cvt_pk_bf16_f32 v52, v48, v49
v_cvt_pk_bf16_f32 v53, v50, v51
v_lshlrev_b32 v48, 16, v52
v_and_b32 v49, 0xffff0000, v52
v_lshlrev_b32 v50, 16, v53
v_and_b32 v51, 0xffff0000, v53
v_max3_f32 v52, v48, v49, v50
v_max_f32 v52, v52, v51
v_mov_b32 v53, v52
s_nop 1
v_permlane32_swap_b32 v52, v53
v_max_f32 v52, v52, v53
v_mov_b32 v53, v52
s_nop 1
v_permlane16_swap_b32 v52, v53
v_max3_f32 v52, v52, v53, v40
v_sub_f32 v53, v40, v52
v_mul_f32 v53, s34, v53
v_exp_f32 v53, v53
v_mov_b32 v40, v52
v_mul_f32 v54, s34, v52
v_fma_f32 v48, v48, s34, -v54
v_fma_f32 v49, v49, s34, -v54
v_fma_f32 v50, v50, s34, -v54
v_fma_f32 v51, v51, s34, -v54
v_exp_f32 v48, v48
v_exp_f32 v49, v49
v_exp_f32 v50, v50
v_exp_f32 v51, v51
v_mul_f32 v44, v44, v53
v_mul_f32 v45, v45, v53
v_mul_f32 v46, v46, v53
v_mul_f32 v47, v47, v53
v_fma_f32 v41, v41, v53, v48
v_add_f32 v55, v49, v50
v_add_f32 v41, v41, v51
v_add_f32 v41, v41, v55
v_cvt_pk_bf16_f32 v56, v48, v49
v_cvt_pk_bf16_f32 v57, v50, v51
s_waitcnt vmcnt(12)
v_perm_b32 v8, v56, v56, v16
v_perm_b32 v9, v56, v56, v17
v_perm_b32 v10, v56, v56, v18
v_perm_b32 v11, v56, v56, v19
s_nop 1
v_mfma_f32_16x16x32_bf16 v[44:47], v[80:83], v[8:11], v[44:47]
v_perm_b32 v12, v56, v56, v20
v_perm_b32 v13, v56, v56, v21
v_perm_b32 v14, v56, v56, v22
v_perm_b32 v15, v56, v56, v23
s_nop 1
v_mfma_f32_16x16x32_bf16 v[44:47], v[84:87], v[12:15], v[44:47]
v_perm_b32 v8, v57, v57, v16
v_perm_b32 v9, v57, v57, v17
v_perm_b32 v10, v57, v57, v18
v_perm_b32 v11, v57, v57, v19
s_nop 1
v_mfma_f32_16x16x32_bf16 v[44:47], v[88:91], v[8:11], v[44:47]
v_perm_b32 v12, v57, v57, v20
v_perm_b32 v13, v57, v57, v21
v_perm_b32 v14, v57, v57, v22
v_perm_b32 v15, v57, v57, v23
s_nop 1
v_mfma_f32_16x16x32_bf16 v[44:47], v[92:95], v[12:15], v[44:47]
buffer_load_dwordx4 v[80:83], v6, s[24:27], s32 offen offset:0 nt
buffer_load_dwordx4 v[84:87], v6, s[24:27], s32 offen offset:1024 nt
buffer_load_dwordx4 v[88:91], v6, s[24:27], s32 offen offset:2048 nt
buffer_load_dwordx4 v[92:95], v6, s[24:27], s32 offen offset:3072 nt
s_add_u32 s32, s32, 16384
s_waitcnt vmcnt(12)
v_mfma_f32_16x16x32_bf16 v[48:51], v[96:99], v[24:27], 0
v_mfma_f32_16x16x32_bf16 v[48:51], v[100:103], v[28:31], v[48:51]
v_mfma_f32_16x16x32_bf16 v[48:51], v[104:107], v[32:35], v[48:51]
v_mfma_f32_16x16x32_bf16 v[48:51], v[108:111], v[36:39], v[48:51]
buffer_load_dwordx4 v[96:99], v5, s[20:23], s32 offen offset:0 nt
buffer_load_dwordx4 v[100:103], v5, s[20:23], s32 offen offset:64 nt
buffer_load_dwordx4 v[104:107], v5, s[20:23], s32 offen offset:128 nt
buffer_load_dwordx4 v[108:111], v5, s[20:23], s32 offen offset:192 nt
s_nop 3
v_cvt_pk_bf16_f32 v52, v48, v49
v_cvt_pk_bf16_f32 v53, v50, v51
v_lshlrev_b32 v48, 16, v52
v_and_b32 v49, 0xffff0000, v52
v_lshlrev_b32 v50, 16, v53
v_and_b32 v51, 0xffff0000, v53
v_mul_f32 v48, s33, v48
v_mul_f32 v49, s33, v49
v_mul_f32 v50, s33, v50
v_mul_f32 v51, s33, v51
v_cvt_pk_bf16_f32 v52, v48, v49
v_cvt_pk_bf16_f32 v53, v50, v51
v_lshlrev_b32 v48, 16, v52
v_and_b32 v49, 0xffff0000, v52
v_lshlrev_b32 v50, 16, v53
v_and_b32 v51, 0xffff0000, v53
v_max3_f32 v52, v48, v49, v50
v_max_f32 v52, v52, v51
v_mov_b32 v53, v52
s_nop 1
v_permlane32_swap_b32 v52, v53
v_max_f32 v52, v52, v53
v_mov_b32 v53, v52
s_nop 1
v_permlane16_swap_b32 v52, v53
v_max3_f32 v52, v52, v53, v40
v_sub_f32 v53, v40, v52
v_mul_f32 v53, s34, v53
v_exp_f32 v53, v53
v_mov_b32 v40, v52
v_mul_f32 v54, s34, v52
v_fma_f32 v48, v48, s34, -v54
v_fma_f32 v49, v49, s34, -v54
v_fma_f32 v50, v50, s34, -v54
v_fma_f32 v51, v51, s34, -v54
v_exp_f32 v48, v48
v_exp_f32 v49, v49
v_exp_f32 v50, v50
v_exp_f32 v51, v51
v_mul_f32 v44, v44, v53
v_mul_f32 v45, v45, v53
v_mul_f32 v46, v46, v53
v_mul_f32 v47, v47, v53
v_fma_f32 v41, v41, v53, v48
v_add_f32 v55, v49, v50
v_add_f32 v41, v41, v51
v_add_f32 v41, v41, v55
v_cvt_pk_bf16_f32 v56, v48, v49
v_cvt_pk_bf16_f32 v57, v50, v51
s_waitcnt vmcnt(12)
v_perm_b32 v8, v56, v56, v16
v_perm_b32 v9, v56, v56, v17
v_perm_b32 v10, v56, v56, v18
v_perm_b32 v11, v56, v56, v19
s_nop 1
v_mfma_f32_16x16x32_bf16 v[44:47], v[112:115], v[8:11], v[44:47]
v_perm_b32 v12, v56, v56, v20
v_perm_b32 v13, v56, v56, v21
v_perm_b32 v14, v56, v56, v22
v_perm_b32 v15, v56, v56, v23
s_nop 1
v_mfma_f32_16x16x32_bf16 v[44:47], v[116:119], v[12:15], v[44:47]
v_perm_b32 v8, v57, v57, v16
v_perm_b32 v9, v57, v57, v17
v_perm_b32 v10, v57, v57, v18
v_perm_b32 v11, v57, v57, v19
s_nop 1
v_mfma_f32_16x16x32_bf16 v[44:47], v[120:123], v[8:11], v[44:47]
v_perm_b32 v12, v57, v57, v20
v_perm_b32 v13, v57, v57, v21
v_perm_b32 v14, v57, v57, v22
v_perm_b32 v15, v57, v57, v23
s_nop 1
v_mfma_f32_16x16x32_bf16 v[44:47], v[124:127], v[12:15], v[44:47]
buffer_load_dwordx4 v[112:115], v6, s[24:27], s32 offen offset:0 nt
buffer_load_dwordx4 v[116:119], v6, s[24:27], s32 offen offset:1024 nt
buffer_load_dwordx4 v[120:123], v6, s[24:27], s32 offen offset:2048 nt
buffer_load_dwordx4 v[124:127], v6, s[24:27], s32 offen offset:3072 nt
s_add_u32 s32, s32, 16384
s_sub_u32 s35, s35, 1
s_cmp_lg_u32 s35, 0
s_cbranch_scc1 L_loop
s_waitcnt vmcnt(12)
v_mfma_f32_16x16x32_bf16 v[48:51], v[64:67], v[24:27], 0
v_mfma_f32_16x16x32_bf16 v[48:51], v[68:71], v[28:31], v[48:51]
v_mfma_f32_16x16x32_bf16 v[48:51], v[72:75], v[32:35], v[48:51]
v_mfma_f32_16x16x32_bf16 v[48:51], v[76:79], v[36:39], v[48:51]
v_mov_b32 v58, 1
v_mov_b32 v59, 0
s_mov_b64 exec, 1
buffer_atomic_add_x2 v[58:59], v2, s[72:75], s28 offen sc0
s_mov_b64 exec, -1
buffer_load_dwordx4 v[64:67], v5, s[20:23], s32 offen offset:0 nt
buffer_load_dwordx4 v[68:71], v5, s[20:23], s32 offen offset:64 nt
buffer_load_dwordx4 v[72:75], v5, s[20:23], s32 offen offset:128 nt
buffer_load_dwordx4 v[76:79], v5, s[20:23], s32 offen offset:192 nt
s_nop 3
v_cvt_pk_bf16_f32 v52, v48, v49
v_cvt_pk_bf16_f32 v53, v50, v51
v_lshlrev_b32 v48, 16, v52
v_and_b32 v49, 0xffff0000, v52
v_lshlrev_b32 v50, 16, v53
v_and_b32 v51, 0xffff0000, v53
v_mul_f32 v48, s33, v48
v_mul_f32 v49, s33, v49
v_mul_f32 v50, s33, v50
v_mul_f32 v51, s33, v51
v_cvt_pk_bf16_f32 v52, v48, v49
v_cvt_pk_bf16_f32 v53, v50, v51
v_lshlrev_b32 v48, 16, v52
v_and_b32 v49, 0xffff0000, v52
v_lshlrev_b32 v50, 16, v53
v_and_b32 v51, 0xffff0000, v53
v_max3_f32 v52, v48, v49, v50
v_max_f32 v52, v52, v51
v_mov_b32 v53, v52
s_nop 1
v_permlane32_swap_b32 v52, v53
v_max_f32 v52, v52, v53
v_mov_b32 v53, v52
s_nop 1
v_permlane16_swap_b32 v52, v53
v_max3_f32 v52, v52, v53, v40
v_sub_f32 v53, v40, v52
v_mul_f32 v53, s34, v53
v_exp_f32 v53, v53
v_mov_b32 v40, v52
v_mul_f32 v54, s34, v52
v_fma_f32 v48, v48, s34, -v54
v_fma_f32 v49, v49, s34, -v54
v_fma_f32 v50, v50, s34, -v54
v_fma_f32 v51, v51, s34, -v54
v_exp_f32 v48, v48
v_exp_f32 v49, v49
v_exp_f32 v50, v50
v_exp_f32 v51, v51
v_mul_f32 v44, v44, v53
v_mul_f32 v45, v45, v53
v_mul_f32 v46, v46, v53
v_mul_f32 v47, v47, v53
v_fma_f32 v41, v41, v53, v48
v_add_f32 v55, v49, v50
v_add_f32 v41, v41, v51
v_add_f32 v41, v41, v55
v_cvt_pk_bf16_f32 v56, v48, v49
v_cvt_pk_bf16_f32 v57, v50, v51
s_waitcnt vmcnt(13)
v_perm_b32 v8, v56, v56, v16
v_perm_b32 v9, v56, v56, v17
v_perm_b32 v10, v56, v56, v18
v_perm_b32 v11, v56, v56, v19
s_nop 1
v_mfma_f32_16x16x32_bf16 v[44:47], v[80:83], v[8:11], v[44:47]
v_perm_b32 v12, v56, v56, v20
v_perm_b32 v13, v56, v56, v21
v_perm_b32 v14, v56, v56, v22
v_perm_b32 v15, v56, v56, v23
s_nop 1
v_mfma_f32_16x16x32_bf16 v[44:47], v[84:87], v[12:15], v[44:47]
v_perm_b32 v8, v57, v57, v16
v_perm_b32 v9, v57, v57, v17
v_perm_b32 v10, v57, v57, v18
v_perm_b32 v11, v57, v57, v19
s_nop 1
v_mfma_f32_16x16x32_bf16 v[44:47], v[88:91], v[8:11], v[44:47]
v_perm_b32 v12, v57, v57, v20
v_perm_b32 v13, v57, v57, v21
v_perm_b32 v14, v57, v57, v22
v_perm_b32 v15, v57, v57, v23
s_nop 1
v_mfma_f32_16x16x32_bf16 v[44:47], v[92:95], v[12:15], v[44:47]
buffer_load_dwordx4 v[80:83], v6, s[24:27], s32 offen offset:0 nt
buffer_load_dwordx4 v[84:87], v6, s[24:27], s32 offen offset:1024 nt
buffer_load_dwordx4 v[88:91], v6, s[24:27], s32 offen offset:2048 nt
buffer_load_dwordx4 v[92:95], v6, s[24:27], s32 offen offset:3072 nt
s_add_u32 s32, s32, 16384
s_waitcnt vmcnt(13)
v_mfma_f32_16x16x32_bf16 v[48:51], v[96:99], v[24:27], 0
v_mfma_f32_16x16x32_bf16 v[48:51], v[100:103], v[28:31], v[48:51]
v_mfma_f32_16x16x32_bf16 v[48:51], v[104:107], v[32:35], v[48:51]
v_mfma_f32_16x16x32_bf16 v[48:51], v[108:111], v[36:39], v[48:51]
v_mov_b32 v60, 1
v_mov_b32 v61, 0
s_mov_b64 exec, 1
buffer_atomic_add_x2 v[60:61], v2, s[72:75], s28 offen sc0
s_mov_b64 exec, -1
buffer_load_dwordx4 v[96:99], v5, s[20:23], s32 offen offset:0 nt
buffer_load_dwordx4 v[100:103], v5, s[20:23], s32 offen offset:64 nt
buffer_load_dwordx4 v[104:107], v5, s[20:23], s32 offen offset:128 nt
buffer_load_dwordx4 v[108:111], v5, s[20:23], s32 offen offset:192 nt
s_nop 3
v_cvt_pk_bf16_f32 v52, v48, v49
v_cvt_pk_bf16_f32 v53, v50, v51
v_lshlrev_b32 v48, 16, v52
v_and_b32 v49, 0xffff0000, v52
v_lshlrev_b32 v50, 16, v53
v_and_b32 v51, 0xffff0000, v53
v_mul_f32 v48, s33, v48
v_mul_f32 v49, s33, v49
v_mul_f32 v50, s33, v50
v_mul_f32 v51, s33, v51
v_cvt_pk_bf16_f32 v52, v48, v49
v_cvt_pk_bf16_f32 v53, v50, v51
v_lshlrev_b32 v48, 16, v52
v_and_b32 v49, 0xffff0000, v52
v_lshlrev_b32 v50, 16, v53
v_and_b32 v51, 0xffff0000, v53
v_max3_f32 v52, v48, v49, v50
v_max_f32 v52, v52, v51
v_mov_b32 v53, v52
s_nop 1
v_permlane32_swap_b32 v52, v53
v_max_f32 v52, v52, v53
v_mov_b32 v53, v52
s_nop 1
v_permlane16_swap_b32 v52, v53
v_max3_f32 v52, v52, v53, v40
v_sub_f32 v53, v40, v52
v_mul_f32 v53, s34, v53
v_exp_f32 v53, v53
v_mov_b32 v40, v52
v_mul_f32 v54, s34, v52
v_fma_f32 v48, v48, s34, -v54
v_fma_f32 v49, v49, s34, -v54
v_fma_f32 v50, v50, s34, -v54
v_fma_f32 v51, v51, s34, -v54
v_exp_f32 v48, v48
v_exp_f32 v49, v49
v_exp_f32 v50, v50
v_exp_f32 v51, v51
v_mul_f32 v44, v44, v53
v_mul_f32 v45, v45, v53
v_mul_f32 v46, v46, v53
v_mul_f32 v47, v47, v53
v_fma_f32 v41, v41, v53, v48
v_add_f32 v55, v49, v50
v_add_f32 v41, v41, v51
v_add_f32 v41, v41, v55
v_cvt_pk_bf16_f32 v56, v48, v49
v_cvt_pk_bf16_f32 v57, v50, v51
s_waitcnt vmcnt(14)
v_perm_b32 v8, v56, v56, v16
v_perm_b32 v9, v56, v56, v17
v_perm_b32 v10, v56, v56, v18
v_perm_b32 v11, v56, v56, v19
s_nop 1
v_mfma_f32_16x16x32_bf16 v[44:47], v[112:115], v[8:11], v[44:47]
v_perm_b32 v12, v56, v56, v20
v_perm_b32 v13, v56, v56, v21
v_perm_b32 v14, v56, v56, v22
v_perm_b32 v15, v56, v56, v23
s_nop 1
v_mfma_f32_16x16x32_bf16 v[44:47], v[116:119], v[12:15], v[44:47]
v_perm_b32 v8, v57, v57, v16
v_perm_b32 v9, v57, v57, v17
v_perm_b32 v10, v57, v57, v18
v_perm_b32 v11, v57, v57, v19
s_nop 1
v_mfma_f32_16x16x32_bf16 v[44:47], v[120:123], v[8:11], v[44:47]
v_perm_b32 v12, v57, v57, v20
v_perm_b32 v13, v57, v57, v21
v_perm_b32 v14, v57, v57, v22
v_perm_b32 v15, v57, v57, v23
s_nop 1
v_mfma_f32_16x16x32_bf16 v[44:47], v[124:127], v[12:15], v[44:47]
buffer_load_dwordx4 v[112:115], v6, s[24:27], s32 offen offset:0 nt
buffer_load_dwordx4 v[116:119], v6, s[24:27], s32 offen offset:1024 nt
buffer_load_dwordx4 v[120:123], v6, s[24:27], s32 offen offset:2048 nt
buffer_load_dwordx4 v[124:127], v6, s[24:27], s32 offen offset:3072 nt
s_add_u32 s32, s32, 16384
s_mov_b32 s8, 0
s_mov_b32 s9, 0
L_dyn:
s_cmp_ge_u32 s8, 0x800000
s_cbranch_scc1 L_dend
s_waitcnt vmcnt(13)
v_readfirstlane_b32 s29, v58
v_readfirstlane_b32 s30, v59
v_mfma_f32_16x16x32_bf16 v[48:51], v[64:67], v[24:27], 0
v_mfma_f32_16x16x32_bf16 v[48:51], v[68:71], v[28:31], v[48:51]
v_mfma_f32_16x16x32_bf16 v[48:51], v[72:75], v[32:35], v[48:51]
v_mfma_f32_16x16x32_bf16 v[48:51], v[76:79], v[36:39], v[48:51]
s_cmp_lg_u32 s30, s62
s_cbranch_scc1 L_tslow0
L_tok0:
s_add_u32 s29, s29, 1792
s_min_u32 s29, s29, 4096
s_lshl_b32 s8, s29, 12
v_mov_b32 v58, 1
v_mov_b32 v59, 0
s_mov_b64 exec, 1
buffer_atomic_add_x2 v[58:59], v2, s[72:75], s28 offen sc0
s_mov_b64 exec, -1
buffer_load_dwordx4 v[64:67], v5, s[20:23], s8 offen offset:0 nt
buffer_load_dwordx4 v[68:71], v5, s[20:23], s8 offen offset:64 nt
buffer_load_dwordx4 v[72:75], v5, s[20:23], s8 offen offset:128 nt
buffer_load_dwordx4 v[76:79], v5, s[20:23], s8 offen offset:192 nt
s_nop 3
v_cvt_pk_bf16_f32 v52, v48, v49
v_cvt_pk_bf16_f32 v53, v50, v51
v_lshlrev_b32 v48, 16, v52
v_and_b32 v49, 0xffff0000, v52
v_lshlrev_b32 v50, 16, v53
v_and_b32 v51, 0xffff0000, v53
v_mul_f32 v48, s33, v48
v_mul_f32 v49, s33, v49
v_mul_f32 v50, s33, v50
v_mul_f32 v51, s33, v51
v_cvt_pk_bf16_f32 v52, v48, v49
v_cvt_pk_bf16_f32 v53, v50, v51
v_lshlrev_b32 v48, 16, v52
v_and_b32 v49, 0xffff0000, v52
v_lshlrev_b32 v50, 16, v53
v_and_b32 v51, 0xffff0000, v53
v_max3_f32 v52, v48, v49, v50
v_max_f32 v52, v52, v51
v_mov_b32 v53, v52
s_nop 1
v_permlane32_swap_b32 v52, v53
v_max_f32 v52, v52, v53
v_mov_b32 v53, v52
s_nop 1
v_permlane16_swap_b32 v52, v53
v_max3_f32 v52, v52, v53, v40
v_sub_f32 v53, v40, v52
v_mul_f32 v53, s34, v53
v_exp_f32 v53, v53
v_mov_b32 v40, v52
v_mul_f32 v54, s34, v52
v_fma_f32 v48, v48, s34, -v54
v_fma_f32 v49, v49, s34, -v54
v_fma_f32 v50, v50, s34, -v54
v_fma_f32 v51, v51, s34, -v54
v_exp_f32 v48, v48
v_exp_f32 v49, v49
v_exp_f32 v50, v50
v_exp_f32 v51, v51
v_mul_f32 v44, v44, v53
v_mul_f32 v45, v45, v53
v_mul_f32 v46, v46, v53
v_mul_f32 v47, v47, v53
v_fma_f32 v41, v41, v53, v48
v_add_f32 v55, v49, v50
v_add_f32 v41, v41, v51
v_add_f32 v41, v41, v55
v_cvt_pk_bf16_f32 v56, v48, v49
v_cvt_pk_bf16_f32 v57, v50, v51
s_waitcnt vmcnt(14)
v_perm_b32 v8, v56, v56, v16
v_perm_b32 v9, v56, v56, v17
v_perm_b32 v10, v56, v56, v18
v_perm_b32 v11, v56, v56, v19
s_nop 1
v_mfma_f32_16x16x32_bf16 v[44:47], v[80:83], v[8:11], v[44:47]
v_perm_b32 v12, v56, v56, v20
v_perm_b32 v13, v56, v56, v21
v_perm_b32 v14, v56, v56, v22
v_perm_b32 v15, v56, v56, v23
s_nop 1
v_mfma_f32_16x16x32_bf16 v[44:47], v[84:87], v[12:15], v[44:47]
v_perm_b32 v8, v57, v57, v16
v_perm_b32 v9, v57, v57, v17
v_perm_b32 v10, v57, v57, v18
v_perm_b32 v11, v57, v57, v19
s_nop 1
v_mfma_f32_16x16x32_bf16 v[44:47], v[88:91], v[8:11], v[44:47]
v_perm_b32 v12, v57, v57, v20
v_perm_b32 v13, v57, v57, v21
v_perm_b32 v14, v57, v57, v22
v_perm_b32 v15, v57, v57, v23
s_nop 1
v_mfma_f32_16x16x32_bf16 v[44:47], v[92:95], v[12:15], v[44:47]
buffer_load_dwordx4 v[80:83], v6, s[24:27], s8 offen offset:0 nt
buffer_load_dwordx4 v[84:87], v6, s[24:27], s8 offen offset:1024 nt
buffer_load_dwordx4 v[88:91], v6, s[24:27], s8 offen offset:2048 nt
buffer_load_dwordx4 v[92:95], v6, s[24:27], s8 offen offset:3072 nt
s_cmp_ge_u32 s9, 0x800000
s_cbranch_scc1 L_dend
s_waitcnt vmcnt(13)
v_readfirstlane_b32 s29, v60
v_readfirstlane_b32 s30, v61
v_mfma_f32_16x16x32_bf16 v[48:51], v[96:99], v[24:27], 0
v_mfma_f32_16x16x32_bf16 v[48:51], v[100:103], v[28:31], v[48:51]
v_mfma_f32_16x16x32_bf16 v[48:51], v[104:107], v[32:35], v[48:51]
v_mfma_f32_16x16x32_bf16 v[48:51], v[108:111], v[36:39], v[48:51]
s_cmp_lg_u32 s30, s62
s_cbranch_scc1 L_tslow1
L_tok1:
s_add_u32 s29, s29, 1792
s_min_u32 s29, s29, 4096
s_lshl_b32 s9, s29, 12
v_mov_b32 v60, 1
v_mov_b32 v61, 0
s_mov_b64 exec, 1
buffer_atomic_add_x2 v[60:61], v2, s[72:75], s28 offen sc0
s_mov_b64 exec, -1
buffer_load_dwordx4 v[96:99], v5, s[20:23], s9 offen offset:0 nt
buffer_load_dwordx4 v[100:103], v5, s[20:23], s9 offen offset:64 nt
buffer_load_dwordx4 v[104:107], v5, s[20:23], s9 offen offset:128 nt
buffer_load_dwordx4 v[108:111], v5, s[20:23], s9 offen offset:192 nt
s_nop 3
v_cvt_pk_bf16_f32 v52, v48, v49
v_cvt_pk_bf16_f32 v53, v50, v51
v_lshlrev_b32 v48, 16, v52
v_and_b32 v49, 0xffff0000, v52
v_lshlrev_b32 v50, 16, v53
v_and_b32 v51, 0xffff0000, v53
v_mul_f32 v48, s33, v48
v_mul_f32 v49, s33, v49
v_mul_f32 v50, s33, v50
v_mul_f32 v51, s33, v51
v_cvt_pk_bf16_f32 v52, v48, v49
v_cvt_pk_bf16_f32 v53, v50, v51
v_lshlrev_b32 v48, 16, v52
v_and_b32 v49, 0xffff0000, v52
v_lshlrev_b32 v50, 16, v53
v_and_b32 v51, 0xffff0000, v53
v_max3_f32 v52, v48, v49, v50
v_max_f32 v52, v52, v51
v_mov_b32 v53, v52
s_nop 1
v_permlane32_swap_b32 v52, v53
v_max_f32 v52, v52, v53
v_mov_b32 v53, v52
s_nop 1
v_permlane16_swap_b32 v52, v53
v_max3_f32 v52, v52, v53, v40
v_sub_f32 v53, v40, v52
v_mul_f32 v53, s34, v53
v_exp_f32 v53, v53
v_mov_b32 v40, v52
v_mul_f32 v54, s34, v52
v_fma_f32 v48, v48, s34, -v54
v_fma_f32 v49, v49, s34, -v54
v_fma_f32 v50, v50, s34, -v54
v_fma_f32 v51, v51, s34, -v54
v_exp_f32 v48, v48
v_exp_f32 v49, v49
v_exp_f32 v50, v50
v_exp_f32 v51, v51
v_mul_f32 v44, v44, v53
v_mul_f32 v45, v45, v53
v_mul_f32 v46, v46, v53
v_mul_f32 v47, v47, v53
v_fma_f32 v41, v41, v53, v48
v_add_f32 v55, v49, v50
v_add_f32 v41, v41, v51
v_add_f32 v41, v41, v55
v_cvt_pk_bf16_f32 v56, v48, v49
v_cvt_pk_bf16_f32 v57, v50, v51
s_waitcnt vmcnt(14)
v_perm_b32 v8, v56, v56, v16
v_perm_b32 v9, v56, v56, v17
v_perm_b32 v10, v56, v56, v18
v_perm_b32 v11, v56, v56, v19
s_nop 1
v_mfma_f32_16x16x32_bf16 v[44:47], v[112:115], v[8:11], v[44:47]
v_perm_b32 v12, v56, v56, v20
v_perm_b32 v13, v56, v56, v21
v_perm_b32 v14, v56, v56, v22
v_perm_b32 v15, v56, v56, v23
s_nop 1
v_mfma_f32_16x16x32_bf16 v[44:47], v[116:119], v[12:15], v[44:47]
v_perm_b32 v8, v57, v57, v16
v_perm_b32 v9, v57, v57, v17
v_perm_b32 v10, v57, v57, v18
v_perm_b32 v11, v57, v57, v19
s_nop 1
v_mfma_f32_16x16x32_bf16 v[44:47], v[120:123], v[8:11], v[44:47]
v_perm_b32 v12, v57, v57, v20
v_perm_b32 v13, v57, v57, v21
v_perm_b32 v14, v57, v57, v22
v_perm_b32 v15, v57, v57, v23
s_nop 1
v_mfma_f32_16x16x32_bf16 v[44:47], v[124:127], v[12:15], v[44:47]
buffer_load_dwordx4 v[112:115], v6, s[24:27], s9 offen offset:0 nt
buffer_load_dwordx4 v[116:119], v6, s[24:27], s9 offen offset:1024 nt
buffer_load_dwordx4 v[120:123], v6, s[24:27], s9 offen offset:2048 nt
buffer_load_dwordx4 v[124:127], v6, s[24:27], s9 offen offset:3072 nt
s_branch L_dyn
L_tslow0:
s_mov_b32 s3, 200000
L_tslowb0:
v_mov_b32 v58, 1
v_mov_b32 v59, 0
s_mov_b64 exec, 1
buffer_atomic_add_x2 v[58:59], v2, s[72:75], s28 offen sc0
s_mov_b64 exec, -1
s_waitcnt vmcnt(0)
v_readfirstlane_b32 s29, v58
v_readfirstlane_b32 s30, v59
s_sub_u32 s3, s3, 1
s_cmp_eq_u32 s3, 0
s_cbranch_scc1 L_tgiveup0
s_cmp_lg_u32 s30, s62
s_cbranch_scc1 L_tslowb0
s_branch L_tok0
L_tgiveup0:
s_mov_b32 s29, 4096
s_branch L_tok0
L_tslow1:
s_mov_b32 s3, 200000
L_tslowb1:
v_mov_b32 v60, 1
v_mov_b32 v61, 0
s_mov_b64 exec, 1
buffer_atomic_add_x2 v[60:61], v2, s[72:75], s28 offen sc0
s_mov_b64 exec, -1
s_waitcnt vmcnt(0)
v_readfirstlane_b32 s29, v60
v_readfirstlane_b32 s30, v61
s_sub_u32 s3, s3, 1
s_cmp_eq_u32 s3, 0
s_cbranch_scc1 L_tgiveup1
s_cmp_lg_u32 s30, s62
s_cbranch_scc1 L_tslowb1
s_branch L_tok1
L_tgiveup1:
s_mov_b32 s29, 4096
s_branch L_tok1
L_dend:
v_mov_b32 v53, v41
s_nop 1
v_permlane32_swap_b32 v41, v53
v_add_f32 v41, v41, v53
v_mov_b32 v53, v41
s_nop 1
v_permlane16_swap_b32 v41, v53
v_add_f32 v41, v41, v53
v_lshrrev_b32 v8, 3, v3
v_lshlrev_b32 v8, 9, v8
v_lshlrev_b32 v9, 7, v4
v_add_u32 v8, v8, v9
v_and_b32 v9, 7, v1
v_lshlrev_b32 v9, 2, v9
v_add_u32 v8, v8, v9
s_lshl_b32 s19, s18, 10
v_add_u32 v8, s19, v8
ds_write_b32 v8, v44 offset:1024
ds_write_b32 v8, v45 offset:1056
ds_write_b32 v8, v46 offset:1088
ds_write_b32 v8, v47 offset:1120
v_lshrrev_b32 v9, 3, v3
v_lshlrev_b32 v9, 3, v9
s_lshl_b32 s19, s18, 4
v_add_u32 v9, s19, v9
ds_write_b64 v9, v[40:41] offset:5120
s_waitcnt lgkmcnt(0)
s_barrier
s_endpgm
L_aux:
s_setprio 3
s_sub_u32 s19, s18, 4
v_lshrrev_b32 v2, 3, v3
v_mul_u32_u24 v2, 1152, v2
s_waitcnt lgkmcnt(0)
s_mov_b32 s64, s36
s_mov_b32 s65, s37
s_mov_b32 s66, 2304
s_mov_b32 s67, 0x20000
s_mov_b32 s72, s60
s_mov_b32 s73, s61
s_mov_b32 s74, 10485760
s_mov_b32 s75, 0x20000
s_load_dword s62, s[60:61], 0x0
s_cmp_lg_u32 s19, 0
s_cbranch_scc1 L_notq
s_mov_b32 s68, s42
s_mov_b32 s69, s43
s_mov_b32 s70, 4718592
s_mov_b32 s71, 0x20000
s_mul_i32 s20, s14, 72
v_mul_u32_u24 v7, 18, v4
v_add_u32 v7, s20, v7
v_lshlrev_b32 v5, 13, v7
v_lshlrev_b32 v8, 4, v3
v_add_u32 v5, v5, v8
s_lshl_b32 s20, s15, 8
v_lshlrev_b32 v7, 1, v7
v_add_u32 v7, v7, v2
buffer_load_dwordx4 v[32:35], v7, s[64:67], 0 offen
buffer_load_dwordx4 v[36:39], v7, s[64:67], 0 offen offset:16
buffer_load_dword v40, v7, s[64:67], 0 offen offset:32
buffer_load_dwordx4 v[60:63], v5, s[68:71], s20 offen nt
s_add_u32 s20, s20, 8192
buffer_load_dwordx4 v[64:67], v5, s[68:71], s20 offen nt
s_add_u32 s20, s20, 8192
buffer_load_dwordx4 v[68:71], v5, s[68:71], s20 offen nt
s_add_u32 s20, s20, 8192
buffer_load_dwordx4 v[72:75], v5, s[68:71], s20 offen nt
s_add_u32 s20, s20, 8192
buffer_load_dwordx4 v[76:79], v5, s[68:71], s20 offen nt
s_add_u32 s20, s20, 8192
buffer_load_dwordx4 v[80:83], v5, s[68:71], s20 offen nt
s_add_u32 s20, s20, 8192
buffer_load_dwordx4 v[84:87], v5, s[68:71], s20 offen nt
s_add_u32 s20, s20, 8192
buffer_load_dwordx4 v[88:91], v5, s[68:71], s20 offen nt
s_add_u32 s20, s20, 8192
buffer_load_dwordx4 v[92:95], v5, s[68:71], s20 offen nt
s_add_u32 s20, s20, 8192
buffer_load_dwordx4 v[96:99], v5, s[68:71], s20 offen nt
s_add_u32 s20, s20, 8192
buffer_load_dwordx4 v[100:103], v5, s[68:71], s20 offen nt
s_add_u32 s20, s20, 8192
buffer_load_dwordx4 v[104:107], v5, s[68:71], s20 offen nt
s_add_u32 s20, s20, 8192
buffer_load_dwordx4 v[108:111], v5, s[68:71], s20 offen nt
s_add_u32 s20, s20, 8192
buffer_load_dwordx4 v[112:115], v5, s[68:71], s20 offen nt
s_add_u32 s20, s20, 8192
buffer_load_dwordx4 v[116:119], v5, s[68:71], s20 offen nt
s_add_u32 s20, s20, 8192
buffer_load_dwordx4 v[120:123], v5, s[68:71], s20 offen nt
s_add_u32 s20, s20, 8192
buffer_load_dwordx4 v[124:127], v5, s[68:71], s20 offen nt
s_add_u32 s20, s20, 8192
buffer_load_dwordx4 v[128:131], v5, s[68:71], s20 offen nt
s_add_u32 s20, s20, 8192
s_barrier
v_and_b32 v7, 1, v1
v_cmp_eq_u32 vcc, 1, v7
v_mov_b32 v8, 0x0c0c0100
v_mov_b32 v9, 0x01000c0c
v_cndmask_b32 v8, v8, v9, vcc
v_mov_b32 v9, 0x0c0c0302
v_mov_b32 v10, 0x03020c0c
v_cndmask_b32 v9, v9, v10, vcc
v_bfe_u32 v7, v1, 1, 2
v_mov_b32 v10, 0x0c0c0c0c
v_cmp_eq_u32 vcc, 0, v7
s_nop 1
v_cndmask_b32 v16, v10, v8, vcc
v_cndmask_b32 v20, v10, v9, vcc
v_cmp_eq_u32 vcc, 1, v7
s_nop 1
v_cndmask_b32 v17, v10, v8, vcc
v_cndmask_b32 v21, v10, v9, vcc
v_cmp_eq_u32 vcc, 2, v7
s_nop 1
v_cndmask_b32 v18, v10, v8, vcc
v_cndmask_b32 v22, v10, v9, vcc
v_cmp_eq_u32 vcc, 3, v7
s_nop 1
v_cndmask_b32 v19, v10, v8, vcc
v_cndmask_b32 v23, v10, v9, vcc
v_mov_b32 v6, 0
ds_write_b32 v6, v6 offset:7680
v_lshrrev_b32 v6, 3, v3
v_lshlrev_b32 v6, 10, v6
v_lshlrev_b32 v7, 7, v4
v_add_u32 v6, v6, v7
v_and_b32 v7, 7, v1
v_lshlrev_b32 v7, 4, v7
v_add_u32 v6, v6, v7
s_lshl_b32 s20, s2, 11
s_add_u32 s20, s20, 6291456
s_waitcnt lgkmcnt(0)
s_add_u32 s62, s62, 1
s_xor_b32 s63, s62, 0x5bd1e995
v_mov_b32 v29, s62
v_mov_b32 v31, s63
v_mov_b32 v57, s62
v_mov_b32 v59, s63
s_waitcnt vmcnt(17)
v_perm_b32 v8, v32, v32, v16
v_perm_b32 v9, v32, v32, v17
v_perm_b32 v10, v32, v32, v18
v_perm_b32 v11, v32, v32, v19
s_nop 1
v_mfma_f32_16x16x32_bf16 v[24:27], v[60:63], v[8:11], 0
s_waitcnt vmcnt(16)
v_perm_b32 v12, v32, v32, v20
v_perm_b32 v13, v32, v32, v21
v_perm_b32 v14, v32, v32, v22
v_perm_b32 v15, v32, v32, v23
s_nop 1
v_mfma_f32_16x16x32_bf16 v[24:27], v[64:67], v[12:15], v[24:27]
s_waitcnt vmcnt(15)
v_perm_b32 v8, v33, v33, v16
v_perm_b32 v9, v33, v33, v17
v_perm_b32 v10, v33, v33, v18
v_perm_b32 v11, v33, v33, v19
s_nop 1
v_mfma_f32_16x16x32_bf16 v[24:27], v[68:71], v[8:11], v[24:27]
s_waitcnt vmcnt(14)
v_perm_b32 v12, v33, v33, v20
v_perm_b32 v13, v33, v33, v21
v_perm_b32 v14, v33, v33, v22
v_perm_b32 v15, v33, v33, v23
s_nop 1
v_mfma_f32_16x16x32_bf16 v[24:27], v[72:75], v[12:15], v[24:27]
s_waitcnt vmcnt(13)
v_perm_b32 v8, v34, v34, v16
v_perm_b32 v9, v34, v34, v17
v_perm_b32 v10, v34, v34, v18
v_perm_b32 v11, v34, v34, v19
s_nop 1
v_mfma_f32_16x16x32_bf16 v[24:27], v[76:79], v[8:11], v[24:27]
s_waitcnt vmcnt(12)
v_perm_b32 v12, v34, v34, v20
v_perm_b32 v13, v34, v34, v21
v_perm_b32 v14, v34, v34, v22
v_perm_b32 v15, v34, v34, v23
s_nop 1
v_mfma_f32_16x16x32_bf16 v[24:27], v[80:83], v[12:15], v[24:27]
s_waitcnt vmcnt(11)
v_perm_b32 v8, v35, v35, v16
v_perm_b32 v9, v35, v35, v17
v_perm_b32 v10, v35, v35, v18
v_perm_b32 v11, v35, v35, v19
s_nop 1
v_mfma_f32_16x16x32_bf16 v[24:27], v[84:87], v[8:11], v[24:27]
s_waitcnt vmcnt(10)
v_perm_b32 v12, v35, v35, v20
v_perm_b32 v13, v35, v35, v21
v_perm_b32 v14, v35, v35, v22
v_perm_b32 v15, v35, v35, v23
s_nop 1
v_mfma_f32_16x16x32_bf16 v[24:27], v[88:91], v[12:15], v[24:27]
s_waitcnt vmcnt(9)
v_perm_b32 v8, v36, v36, v16
v_perm_b32 v9, v36, v36, v17
v_perm_b32 v10, v36, v36, v18
v_perm_b32 v11, v36, v36, v19
s_nop 1
v_mfma_f32_16x16x32_bf16 v[24:27], v[92:95], v[8:11], v[24:27]
s_waitcnt vmcnt(8)
v_perm_b32 v12, v36, v36, v20
v_perm_b32 v13, v36, v36, v21
v_perm_b32 v14, v36, v36, v22
v_perm_b32 v15, v36, v36, v23
s_nop 1
v_mfma_f32_16x16x32_bf16 v[24:27], v[96:99], v[12:15], v[24:27]
s_waitcnt vmcnt(7)
v_perm_b32 v8, v37, v37, v16
v_perm_b32 v9, v37, v37, v17
v_perm_b32 v10, v37, v37, v18
v_perm_b32 v11, v37, v37, v19
s_nop 1
v_mfma_f32_16x16x32_bf16 v[24:27], v[100:103], v[8:11], v[24:27]
s_waitcnt vmcnt(6)
v_perm_b32 v12, v37, v37, v20
v_perm_b32 v13, v37, v37, v21
v_perm_b32 v14, v37, v37, v22
v_perm_b32 v15, v37, v37, v23
s_nop 1
v_mfma_f32_16x16x32_bf16 v[24:27], v[104:107], v[12:15], v[24:27]
s_waitcnt vmcnt(5)
v_perm_b32 v8, v38, v38, v16
v_perm_b32 v9, v38, v38, v17
v_perm_b32 v10, v38, v38, v18
v_perm_b32 v11, v38, v38, v19
s_nop 1
v_mfma_f32_16x16x32_bf16 v[24:27], v[108:111], v[8:11], v[24:27]
s_waitcnt vmcnt(4)
v_perm_b32 v12, v38, v38, v20
v_perm_b32 v13, v38, v38, v21
v_perm_b32 v14, v38, v38, v22
v_perm_b32 v15, v38, v38, v23
s_nop 1
v_mfma_f32_16x16x32_bf16 v[24:27], v[112:115], v[12:15], v[24:27]
s_waitcnt vmcnt(3)
v_perm_b32 v8, v39, v39, v16
v_perm_b32 v9, v39, v39, v17
v_perm_b32 v10, v39, v39, v18
v_perm_b32 v11, v39, v39, v19
s_nop 1
v_mfma_f32_16x16x32_bf16 v[24:27], v[116:119], v[8:11], v[24:27]
s_waitcnt vmcnt(2)
v_perm_b32 v12, v39, v39, v20
v_perm_b32 v13, v39, v39, v21
v_perm_b32 v14, v39, v39, v22
v_perm_b32 v15, v39, v39, v23
s_nop 1
v_mfma_f32_16x16x32_bf16 v[24:27], v[120:123], v[12:15], v[24:27]
s_waitcnt vmcnt(1)
v_perm_b32 v8, v40, v40, v16
v_perm_b32 v9, v40, v40, v17
v_perm_b32 v10, v40, v40, v18
v_perm_b32 v11, v40, v40, v19
s_nop 1
v_mfma_f32_16x16x32_bf16 v[24:27], v[124:127], v[8:11], v[24:27]
s_waitcnt vmcnt(0)
v_perm_b32 v12, v40, v40, v20
v_perm_b32 v13, v40, v40, v21
v_perm_b32 v14, v40, v40, v22
v_perm_b32 v15, v40, v40, v23
s_nop 1
v_mfma_f32_16x16x32_bf16 v[24:27], v[128:131], v[12:15], v[24:27]
v_lshlrev_b32 v8, 4, v1
s_lshl_b32 s21, s12, 15
s_lshl_b32 s22, s13, 10
s_add_u32 s21, s21, s22
s_add_u32 s21, s21, 6291456
v_bfe_u32 v12, v1, 3, 2
v_lshlrev_b32 v12, 6, v12
v_lshrrev_b32 v13, 5, v1
v_lshlrev_b32 v13, 5, v13
v_and_b32 v14, 7, v1
v_lshlrev_b32 v14, 1, v14
v_add3_u32 v12, v12, v13, v14
v_mov_b32 v28, v24
v_mov_b32 v30, v25
v_mov_b32 v56, v26
v_mov_b32 v58, v27
buffer_store_dwordx4 v[28:31], v6, s[72:75], s20 offen sc1
buffer_store_dwordx4 v[56:59], v6, s[72:75], s20 offen offset:512 sc1
s_mov_b32 s24, 200000
L_qpoll:
s_mov_b32 s22, s21
buffer_load_dwordx4 v[60:63], v8, s[72:75], s22 offen offset:0 sc1
buffer_load_dwordx4 v[64:67], v8, s[72:75], s22 offen offset:2048 sc1
s_add_u32 s22, s22, 4096
buffer_load_dwordx4 v[68:71], v8, s[72:75], s22 offen offset:0 sc1
buffer_load_dwordx4 v[72:75], v8, s[72:75], s22 offen offset:2048 sc1
s_add_u32 s22, s22, 4096
buffer_load_dwordx4 v[76:79], v8, s[72:75], s22 offen offset:0 sc1
buffer_load_dwordx4 v[80:83], v8, s[72:75], s22 offen offset:2048 sc1
s_add_u32 s22, s22, 4096
buffer_load_dwordx4 v[84:87], v8, s[72:75], s22 offen offset:0 sc1
buffer_load_dwordx4 v[88:91], v8, s[72:75], s22 offen offset:2048 sc1
s_add_u32 s22, s22, 4096
buffer_load_dwordx4 v[92:95], v8, s[72:75], s22 offen offset:0 sc1
buffer_load_dwordx4 v[96:99], v8, s[72:75], s22 offen offset:2048 sc1
s_add_u32 s22, s22, 4096
buffer_load_dwordx4 v[100:103], v8, s[72:75], s22 offen offset:0 sc1
buffer_load_dwordx4 v[104:107], v8, s[72:75], s22 offen offset:2048 sc1
s_add_u32 s22, s22, 4096
buffer_load_dwordx4 v[108:111], v8, s[72:75], s22 offen offset:0 sc1
buffer_load_dwordx4 v[112:115], v8, s[72:75], s22 offen offset:2048 sc1
s_add_u32 s22, s22, 4096
buffer_load_dwordx4 v[116:119], v8, s[72:75], s22 offen offset:0 sc1
buffer_load_dwordx4 v[120:123], v8, s[72:75], s22 offen offset:2048 sc1
v_mov_b32 v9, 0
s_waitcnt vmcnt(0)
v_xor_b32 v10, s62, v61
v_xor_b32 v13, s63, v63
v_or3_b32 v9, v9, v10, v13
v_xor_b32 v10, s62, v65
v_xor_b32 v13, s63, v67
v_or3_b32 v9, v9, v10, v13
v_xor_b32 v10, s62, v69
v_xor_b32 v13, s63, v71
v_or3_b32 v9, v9, v10, v13
v_xor_b32 v10, s62, v73
v_xor_b32 v13, s63, v75
v_or3_b32 v9, v9, v10, v13
v_xor_b32 v10, s62, v77
v_xor_b32 v13, s63, v79
v_or3_b32 v9, v9, v10, v13
v_xor_b32 v10, s62, v81
v_xor_b32 v13, s63, v83
v_or3_b32 v9, v9, v10, v13
v_xor_b32 v10, s62, v85
v_xor_b32 v13, s63, v87
v_or3_b32 v9, v9, v10, v13
v_xor_b32 v10, s62, v89
v_xor_b32 v13, s63, v91
v_or3_b32 v9, v9, v10, v13
v_xor_b32 v10, s62, v93
v_xor_b32 v13, s63, v95
v_or3_b32 v9, v9, v10, v13
v_xor_b32 v10, s62, v97
v_xor_b32 v13, s63, v99
v_or3_b32 v9, v9, v10, v13
v_xor_b32 v10, s62, v101
v_xor_b32 v13, s63, v103
v_or3_b32 v9, v9, v10, v13
v_xor_b32 v10, s62, v105
v_xor_b32 v13, s63, v107
v_or3_b32 v9, v9, v10, v13
v_xor_b32 v10, s62, v109
v_xor_b32 v13, s63, v111
v_or3_b32 v9, v9, v10, v13
v_xor_b32 v10, s62, v113
v_xor_b32 v13, s63, v115
v_or3_b32 v9, v9, v10, v13
v_xor_b32 v10, s62, v117
v_xor_b32 v13, s63, v119
v_or3_b32 v9, v9, v10, v13
v_xor_b32 v10, s62, v121
v_xor_b32 v13, s63, v123
v_or3_b32 v9, v9, v10, v13
v_cmp_ne_u32 vcc, 0, v9
s_sub_u32 s24, s24, 1
s_cmp_eq_u32 s24, 0
s_cbranch_scc1 L_qdone
s_cbranch_vccnz L_qpoll
L_qdone:
v_add_f32 v60, v60, v64
v_add_f32 v60, v60, v68
v_add_f32 v60, v60, v72
v_add_f32 v60, v60, v76
v_add_f32 v60, v60, v80
v_add_f32 v60, v60, v84
v_add_f32 v60, v60, v88
v_cvt_pk_bf16_f32 v60, v60, v60
ds_write_b16 v12, v60 offset:0
v_add_f32 v62, v62, v66
v_add_f32 v62, v62, v70
v_add_f32 v62, v62, v74
v_add_f32 v62, v62, v78
v_add_f32 v62, v62, v82
v_add_f32 v62, v62, v86
v_add_f32 v62, v62, v90
v_cvt_pk_bf16_f32 v62, v62, v62
ds_write_b16 v12, v62 offset:16
v_add_f32 v92, v92, v96
v_add_f32 v92, v92, v100
v_add_f32 v92, v92, v104
v_add_f32 v92, v92, v108
v_add_f32 v92, v92, v112
v_add_f32 v92, v92, v116
v_add_f32 v92, v92, v120
v_cvt_pk_bf16_f32 v92, v92, v92
ds_write_b16 v12, v92 offset:256
v_add_f32 v94, v94, v98
v_add_f32 v94, v94, v102
v_add_f32 v94, v94, v106
v_add_f32 v94, v94, v110
v_add_f32 v94, v94, v114
v_add_f32 v94, v94, v118
v_add_f32 v94, v94, v122
v_cvt_pk_bf16_f32 v94, v94, v94
ds_write_b16 v12, v94 offset:272
s_waitcnt lgkmcnt(0)
s_branch L_bar1
L_notq:
s_barrier
v_and_b32 v7, 1, v1
v_cmp_eq_u32 vcc, 1, v7
v_mov_b32 v8, 0x0c0c0100
v_mov_b32 v9, 0x01000c0c
v_cndmask_b32 v8, v8, v9, vcc
v_mov_b32 v9, 0x0c0c0302
v_mov_b32 v10, 0x03020c0c
v_cndmask_b32 v9, v9, v10, vcc
v_bfe_u32 v7, v1, 1, 2
v_mov_b32 v10, 0x0c0c0c0c
v_cmp_eq_u32 vcc, 0, v7
s_nop 1
v_cndmask_b32 v16, v10, v8, vcc
v_cndmask_b32 v20, v10, v9, vcc
v_cmp_eq_u32 vcc, 1, v7
s_nop 1
v_cndmask_b32 v17, v10, v8, vcc
v_cndmask_b32 v21, v10, v9, vcc
v_cmp_eq_u32 vcc, 2, v7
s_nop 1
v_cndmask_b32 v18, v10, v8, vcc
v_cndmask_b32 v22, v10, v9, vcc
v_cmp_eq_u32 vcc, 3, v7
s_nop 1
v_cndmask_b32 v19, v10, v8, vcc
v_cndmask_b32 v23, v10, v9, vcc
s_waitcnt lgkmcnt(0)
s_add_u32 s62, s62, 1
s_xor_b32 s63, s62, 0x5bd1e995
s_cmp_lg_u32 s19, 1
s_cbranch_scc1 L_bar1
s_cmp_lg_u32 s14, 0
s_cbranch_scc1 L_bar1
s_lshl_b32 s20, s15, 8
s_add_u32 s20, s20, 6815744
v_mov_b32 v24, 0
v_mov_b32 v25, s62
v_mov_b32 v26, 0
s_mov_b64 exec, 1
buffer_store_dwordx2 v[24:25], v26, s[72:75], s20 offen sc1
s_mov_b64 exec, -1
L_bar1:
s_barrier
s_cmp_lg_u32 s14, 7
s_cbranch_scc1 L_noffn
s_lshr_b32 s20, s19, 1
s_cmp_eq_u32 s20, 0
s_cselect_b32 s84, s48, s50
s_cselect_b32 s85, s49, s51
s_mov_b32 s86, 5308416
s_mov_b32 s87, 0x20000
s_mov_b32 s92, s52
s_mov_b32 s93, s53
s_mov_b32 s94, 5308416
s_mov_b32 s95, 0x20000
v_mul_u32_u24 v5, 331776, v4
v_lshlrev_b32 v6, 4, v3
v_add_u32 v5, v5, v6
s_mul_i32 s20, s15, 288
s_and_b32 s21, s19, 1
s_mul_i32 s21, s21, 144
s_add_u32 s20, s20, s21
v_add_u32 v5, s20, v5
v_mul_u32_u24 v7, 72, v4
v_add_u32 v6, v2, v7
s_mov_b32 s21, 0
s_mov_b32 s23, 0
s_mov_b32 s24, 4
s_mov_b32 s26, 0x01ff01ff
s_mov_b32 s27, 0x01ff01ff
v_mov_b32 v24, 0
v_mov_b32 v25, 0
v_mov_b32 v26, 0
v_mov_b32 v27, 0
L_ffn1:
buffer_load_dwordx4 v[32:35], v6, s[64:67], s23 offen offset:0
buffer_load_dwordx4 v[36:39], v6, s[64:67], s23 offen offset:16
buffer_load_dwordx4 v[40:43], v6, s[64:67], s23 offen offset:32
buffer_load_dwordx4 v[44:47], v6, s[64:67], s23 offen offset:48
buffer_load_dwordx2 v[48:49], v6, s[64:67], s23 offen offset:64
s_mov_b64 exec, s[26:27]
buffer_load_dwordx4 v[60:63], v5, s[84:87], s21 offen nt
s_add_u32 s21, s21, 9216
buffer_load_dwordx4 v[64:67], v5, s[84:87], s21 offen nt
s_add_u32 s21, s21, 9216
buffer_load_dwordx4 v[68:71], v5, s[84:87], s21 offen nt
s_add_u32 s21, s21, 9216
buffer_load_dwordx4 v[72:75], v5, s[84:87], s21 offen nt
s_add_u32 s21, s21, 9216
buffer_load_dwordx4 v[76:79], v5, s[84:87], s21 offen nt
s_add_u32 s21, s21, 9216
buffer_load_dwordx4 v[80:83], v5, s[84:87], s21 offen nt
s_add_u32 s21, s21, 9216
buffer_load_dwordx4 v[84:87], v5, s[84:87], s21 offen nt
s_add_u32 s21, s21, 9216
buffer_load_dwordx4 v[88:91], v5, s[84:87], s21 offen nt
s_add_u32 s21, s21, 9216
buffer_load_dwordx4 v[92:95], v5, s[84:87], s21 offen nt
s_add_u32 s21, s21, 9216
buffer_load_dwordx4 v[96:99], v5, s[84:87], s21 offen nt
s_add_u32 s21, s21, 9216
buffer_load_dwordx4 v[100:103], v5, s[84:87], s21 offen nt
s_add_u32 s21, s21, 9216
buffer_load_dwordx4 v[104:107], v5, s[84:87], s21 offen nt
s_add_u32 s21, s21, 9216
buffer_load_dwordx4 v[108:111], v5, s[84:87], s21 offen nt
s_add_u32 s21, s21, 9216
buffer_load_dwordx4 v[112:115], v5, s[84:87], s21 offen nt
s_add_u32 s21, s21, 9216
buffer_load_dwordx4 v[116:119], v5, s[84:87], s21 offen nt
s_add_u32 s21, s21, 9216
buffer_load_dwordx4 v[120:123], v5, s[84:87], s21 offen nt
s_add_u32 s21, s21, 9216
buffer_load_dwordx4 v[124:127], v5, s[84:87], s21 offen nt
s_add_u32 s21, s21, 9216
buffer_load_dwordx4 v[128:131], v5, s[84:87], s21 offen nt
s_add_u32 s21, s21, 9216
buffer_load_dwordx4 v[132:135], v5, s[84:87], s21 offen nt
s_add_u32 s21, s21, 9216
buffer_load_dwordx4 v[136:139], v5, s[84:87], s21 offen nt
s_add_u32 s21, s21, 9216
buffer_load_dwordx4 v[140:143], v5, s[84:87], s21 offen nt
s_add_u32 s21, s21, 9216
buffer_load_dwordx4 v[144:147], v5, s[84:87], s21 offen nt
s_add_u32 s21, s21, 9216
buffer_load_dwordx4 v[148:151], v5, s[84:87], s21 offen nt
s_add_u32 s21, s21, 9216
buffer_load_dwordx4 v[152:155], v5, s[84:87], s21 offen nt
s_add_u32 s21, s21, 9216
buffer_load_dwordx4 v[156:159], v5, s[84:87], s21 offen nt
s_add_u32 s21, s21, 9216
buffer_load_dwordx4 v[160:163], v5, s[84:87], s21 offen nt
s_add_u32 s21, s21, 9216
buffer_load_dwordx4 v[164:167], v5, s[84:87], s21 offen nt
s_add_u32 s21, s21, 9216
buffer_load_dwordx4 v[168:171], v5, s[84:87], s21 offen nt
s_add_u32 s21, s21, 9216
buffer_load_dwordx4 v[172:175], v5, s[84:87], s21 offen nt
s_add_u32 s21, s21, 9216
buffer_load_dwordx4 v[176:179], v5, s[84:87], s21 offen nt
s_add_u32 s21, s21, 9216
buffer_load_dwordx4 v[180:183], v5, s[84:87], s21 offen nt
s_add_u32 s21, s21, 9216
buffer_load_dwordx4 v[184:187], v5, s[84:87], s21 offen nt
s_add_u32 s21, s21, 9216
buffer_load_dwordx4 v[188:191], v5, s[84:87], s21 offen nt
s_add_u32 s21, s21, 9216
buffer_load_dwordx4 v[192:195], v5, s[84:87], s21 offen nt
s_add_u32 s21, s21, 9216
buffer_load_dwordx4 v[196:199], v5, s[84:87], s21 offen nt
s_add_u32 s21, s21, 9216
buffer_load_dwordx4 v[200:203], v5, s[84:87], s21 offen nt
s_add_u32 s21, s21, 9216
s_mov_b64 exec, -1
s_add_u32 s21, s21, 995328
s_add_u32 s23, s23, 288
s_waitcnt vmcnt(35)
v_perm_b32 v8, v32, v32, v16
v_perm_b32 v9, v32, v32, v17
v_perm_b32 v10, v32, v32, v18
v_perm_b32 v11, v32, v32, v19
s_nop 1
v_mfma_f32_16x16x32_bf16 v[24:27], v[60:63], v[8:11], v[24:27]
s_waitcnt vmcnt(34)
v_perm_b32 v12, v32, v32, v20
v_perm_b32 v13, v32, v32, v21
v_perm_b32 v14, v32, v32, v22
v_perm_b32 v15, v32, v32, v23
s_nop 1
v_mfma_f32_16x16x32_bf16 v[24:27], v[64:67], v[12:15], v[24:27]
s_waitcnt vmcnt(33)
v_perm_b32 v8, v33, v33, v16
v_perm_b32 v9, v33, v33, v17
v_perm_b32 v10, v33, v33, v18
v_perm_b32 v11, v33, v33, v19
s_nop 1
v_mfma_f32_16x16x32_bf16 v[24:27], v[68:71], v[8:11], v[24:27]
s_waitcnt vmcnt(32)
v_perm_b32 v12, v33, v33, v20
v_perm_b32 v13, v33, v33, v21
v_perm_b32 v14, v33, v33, v22
v_perm_b32 v15, v33, v33, v23
s_nop 1
v_mfma_f32_16x16x32_bf16 v[24:27], v[72:75], v[12:15], v[24:27]
s_waitcnt vmcnt(31)
v_perm_b32 v8, v34, v34, v16
v_perm_b32 v9, v34, v34, v17
v_perm_b32 v10, v34, v34, v18
v_perm_b32 v11, v34, v34, v19
s_nop 1
v_mfma_f32_16x16x32_bf16 v[24:27], v[76:79], v[8:11], v[24:27]
s_waitcnt vmcnt(30)
v_perm_b32 v12, v34, v34, v20
v_perm_b32 v13, v34, v34, v21
v_perm_b32 v14, v34, v34, v22
v_perm_b32 v15, v34, v34, v23
s_nop 1
v_mfma_f32_16x16x32_bf16 v[24:27], v[80:83], v[12:15], v[24:27]
s_waitcnt vmcnt(29)
v_perm_b32 v8, v35, v35, v16
v_perm_b32 v9, v35, v35, v17
v_perm_b32 v10, v35, v35, v18
v_perm_b32 v11, v35, v35, v19
s_nop 1
v_mfma_f32_16x16x32_bf16 v[24:27], v[84:87], v[8:11], v[24:27]
s_waitcnt vmcnt(28)
v_perm_b32 v12, v35, v35, v20
v_perm_b32 v13, v35, v35, v21
v_perm_b32 v14, v35, v35, v22
v_perm_b32 v15, v35, v35, v23
s_nop 1
v_mfma_f32_16x16x32_bf16 v[24:27], v[88:91], v[12:15], v[24:27]
s_waitcnt vmcnt(27)
v_perm_b32 v8, v36, v36, v16
v_perm_b32 v9, v36, v36, v17
v_perm_b32 v10, v36, v36, v18
v_perm_b32 v11, v36, v36, v19
s_nop 1
v_mfma_f32_16x16x32_bf16 v[24:27], v[92:95], v[8:11], v[24:27]
s_waitcnt vmcnt(26)
v_perm_b32 v12, v36, v36, v20
v_perm_b32 v13, v36, v36, v21
v_perm_b32 v14, v36, v36, v22
v_perm_b32 v15, v36, v36, v23
s_nop 1
v_mfma_f32_16x16x32_bf16 v[24:27], v[96:99], v[12:15], v[24:27]
s_waitcnt vmcnt(25)
v_perm_b32 v8, v37, v37, v16
v_perm_b32 v9, v37, v37, v17
v_perm_b32 v10, v37, v37, v18
v_perm_b32 v11, v37, v37, v19
s_nop 1
v_mfma_f32_16x16x32_bf16 v[24:27], v[100:103], v[8:11], v[24:27]
s_waitcnt vmcnt(24)
v_perm_b32 v12, v37, v37, v20
v_perm_b32 v13, v37, v37, v21
v_perm_b32 v14, v37, v37, v22
v_perm_b32 v15, v37, v37, v23
s_nop 1
v_mfma_f32_16x16x32_bf16 v[24:27], v[104:107], v[12:15], v[24:27]
s_waitcnt vmcnt(23)
v_perm_b32 v8, v38, v38, v16
v_perm_b32 v9, v38, v38, v17
v_perm_b32 v10, v38, v38, v18
v_perm_b32 v11, v38, v38, v19
s_nop 1
v_mfma_f32_16x16x32_bf16 v[24:27], v[108:111], v[8:11], v[24:27]
s_waitcnt vmcnt(22)
v_perm_b32 v12, v38, v38, v20
v_perm_b32 v13, v38, v38, v21
v_perm_b32 v14, v38, v38, v22
v_perm_b32 v15, v38, v38, v23
s_nop 1
v_mfma_f32_16x16x32_bf16 v[24:27], v[112:115], v[12:15], v[24:27]
s_waitcnt vmcnt(21)
v_perm_b32 v8, v39, v39, v16
v_perm_b32 v9, v39, v39, v17
v_perm_b32 v10, v39, v39, v18
v_perm_b32 v11, v39, v39, v19
s_nop 1
v_mfma_f32_16x16x32_bf16 v[24:27], v[116:119], v[8:11], v[24:27]
s_waitcnt vmcnt(20)
v_perm_b32 v12, v39, v39, v20
v_perm_b32 v13, v39, v39, v21
v_perm_b32 v14, v39, v39, v22
v_perm_b32 v15, v39, v39, v23
s_nop 1
v_mfma_f32_16x16x32_bf16 v[24:27], v[120:123], v[12:15], v[24:27]
s_waitcnt vmcnt(19)
v_perm_b32 v8, v40, v40, v16
v_perm_b32 v9, v40, v40, v17
v_perm_b32 v10, v40, v40, v18
v_perm_b32 v11, v40, v40, v19
s_nop 1
v_mfma_f32_16x16x32_bf16 v[24:27], v[124:127], v[8:11], v[24:27]
s_waitcnt vmcnt(18)
v_perm_b32 v12, v40, v40, v20
v_perm_b32 v13, v40, v40, v21
v_perm_b32 v14, v40, v40, v22
v_perm_b32 v15, v40, v40, v23
s_nop 1
v_mfma_f32_16x16x32_bf16 v[24:27], v[128:131], v[12:15], v[24:27]
s_waitcnt vmcnt(17)
v_perm_b32 v8, v41, v41, v16
v_perm_b32 v9, v41, v41, v17
v_perm_b32 v10, v41, v41, v18
v_perm_b32 v11, v41, v41, v19
s_nop 1
v_mfma_f32_16x16x32_bf16 v[24:27], v[132:135], v[8:11], v[24:27]
s_waitcnt vmcnt(16)
v_perm_b32 v12, v41, v41, v20
v_perm_b32 v13, v41, v41, v21
v_perm_b32 v14, v41, v41, v22
v_perm_b32 v15, v41, v41, v23
s_nop 1
v_mfma_f32_16x16x32_bf16 v[24:27], v[136:139], v[12:15], v[24:27]
s_waitcnt vmcnt(15)
v_perm_b32 v8, v42, v42, v16
v_perm_b32 v9, v42, v42, v17
v_perm_b32 v10, v42, v42, v18
v_perm_b32 v11, v42, v42, v19
s_nop 1
v_mfma_f32_16x16x32_bf16 v[24:27], v[140:143], v[8:11], v[24:27]
s_waitcnt vmcnt(14)
v_perm_b32 v12, v42, v42, v20
v_perm_b32 v13, v42, v42, v21
v_perm_b32 v14, v42, v42, v22
v_perm_b32 v15, v42, v42, v23
s_nop 1
v_mfma_f32_16x16x32_bf16 v[24:27], v[144:147], v[12:15], v[24:27]
s_waitcnt vmcnt(13)
v_perm_b32 v8, v43, v43, v16
v_perm_b32 v9, v43, v43, v17
v_perm_b32 v10, v43, v43, v18
v_perm_b32 v11, v43, v43, v19
s_nop 1
v_mfma_f32_16x16x32_bf16 v[24:27], v[148:151], v[8:11], v[24:27]
s_waitcnt vmcnt(12)
v_perm_b32 v12, v43, v43, v20
v_perm_b32 v13, v43, v43, v21
v_perm_b32 v14, v43, v43, v22
v_perm_b32 v15, v43, v43, v23
s_nop 1
v_mfma_f32_16x16x32_bf16 v[24:27], v[152:155], v[12:15], v[24:27]
s_waitcnt vmcnt(11)
v_perm_b32 v8, v44, v44, v16
v_perm_b32 v9, v44, v44, v17
v_perm_b32 v10, v44, v44, v18
v_perm_b32 v11, v44, v44, v19
s_nop 1
v_mfma_f32_16x16x32_bf16 v[24:27], v[156:159], v[8:11], v[24:27]
s_waitcnt vmcnt(10)
v_perm_b32 v12, v44, v44, v20
v_perm_b32 v13, v44, v44, v21
v_perm_b32 v14, v44, v44, v22
v_perm_b32 v15, v44, v44, v23
s_nop 1
v_mfma_f32_16x16x32_bf16 v[24:27], v[160:163], v[12:15], v[24:27]
s_waitcnt vmcnt(9)
v_perm_b32 v8, v45, v45, v16
v_perm_b32 v9, v45, v45, v17
v_perm_b32 v10, v45, v45, v18
v_perm_b32 v11, v45, v45, v19
s_nop 1
v_mfma_f32_16x16x32_bf16 v[24:27], v[164:167], v[8:11], v[24:27]
s_waitcnt vmcnt(8)
v_perm_b32 v12, v45, v45, v20
v_perm_b32 v13, v45, v45, v21
v_perm_b32 v14, v45, v45, v22
v_perm_b32 v15, v45, v45, v23
s_nop 1
v_mfma_f32_16x16x32_bf16 v[24:27], v[168:171], v[12:15], v[24:27]
s_waitcnt vmcnt(7)
v_perm_b32 v8, v46, v46, v16
v_perm_b32 v9, v46, v46, v17
v_perm_b32 v10, v46, v46, v18
v_perm_b32 v11, v46, v46, v19
s_nop 1
v_mfma_f32_16x16x32_bf16 v[24:27], v[172:175], v[8:11], v[24:27]
s_waitcnt vmcnt(6)
v_perm_b32 v12, v46, v46, v20
v_perm_b32 v13, v46, v46, v21
v_perm_b32 v14, v46, v46, v22
v_perm_b32 v15, v46, v46, v23
s_nop 1
v_mfma_f32_16x16x32_bf16 v[24:27], v[176:179], v[12:15], v[24:27]
s_waitcnt vmcnt(5)
v_perm_b32 v8, v47, v47, v16
v_perm_b32 v9, v47, v47, v17
v_perm_b32 v10, v47, v47, v18
v_perm_b32 v11, v47, v47, v19
s_nop 1
v_mfma_f32_16x16x32_bf16 v[24:27], v[180:183], v[8:11], v[24:27]
s_waitcnt vmcnt(4)
v_perm_b32 v12, v47, v47, v20
v_perm_b32 v13, v47, v47, v21
v_perm_b32 v14, v47, v47, v22
v_perm_b32 v15, v47, v47, v23
s_nop 1
v_mfma_f32_16x16x32_bf16 v[24:27], v[184:187], v[12:15], v[24:27]
s_waitcnt vmcnt(3)
v_perm_b32 v8, v48, v48, v16
v_perm_b32 v9, v48, v48, v17
v_perm_b32 v10, v48, v48, v18
v_perm_b32 v11, v48, v48, v19
s_nop 1
v_mfma_f32_16x16x32_bf16 v[24:27], v[188:191], v[8:11], v[24:27]
s_waitcnt vmcnt(2)
v_perm_b32 v12, v48, v48, v20
v_perm_b32 v13, v48, v48, v21
v_perm_b32 v14, v48, v48, v22
v_perm_b32 v15, v48, v48, v23
s_nop 1
v_mfma_f32_16x16x32_bf16 v[24:27], v[192:195], v[12:15], v[24:27]
s_waitcnt vmcnt(1)
v_perm_b32 v8, v49, v49, v16
v_perm_b32 v9, v49, v49, v17
v_perm_b32 v10, v49, v49, v18
v_perm_b32 v11, v49, v49, v19
s_nop 1
v_mfma_f32_16x16x32_bf16 v[24:27], v[196:199], v[8:11], v[24:27]
s_waitcnt vmcnt(0)
v_perm_b32 v12, v49, v49, v20
v_perm_b32 v13, v49, v49, v21
v_perm_b32 v14, v49, v49, v22
v_perm_b32 v15, v49, v49, v23
s_nop 1
v_mfma_f32_16x16x32_bf16 v[24:27], v[200:203], v[12:15], v[24:27]
s_sub_u32 s24, s24, 1
s_cmp_lg_u32 s24, 0
s_cbranch_scc1 L_ffn1
s_lshr_b32 s20, s19, 1
s_mul_i32 s20, s20, 1152
s_and_b32 s21, s19, 1
s_mul_i32 s21, s21, 288
s_add_u32 s20, s20, s21
v_lshrrev_b32 v8, 3, v3
v_mul_u32_u24 v8, 576, v8
v_lshlrev_b32 v9, 7, v4
v_add_u32 v8, v8, v9
v_and_b32 v9, 7, v1
v_lshlrev_b32 v9, 2, v9
v_add_u32 v8, v8, v9
v_add_u32 v8, s20, v8
s_nop 3
s_mov_b32 exec_lo, -1
s_mov_b32 exec_hi, 0xffff
ds_write_b32 v8, v24 offset:5376
s_mov_b32 exec_hi, 0
ds_write_b32 v8, v25 offset:5408
ds_write_b32 v8, v26 offset:5440
ds_write_b32 v8, v27 offset:5472
s_mov_b64 exec, -1
s_waitcnt lgkmcnt(0)
v_mov_b32 v8, 0
v_mov_b32 v9, 1
s_mov_b64 exec, 1
ds_add_u32 v8, v9 offset:7680
s_mov_b64 exec, -1
s_mul_i32 s20, s15, 144
s_mul_i32 s21, s19, 36
s_add_u32 s20, s20, s21
v_mul_u32_u24 v5, 9, v4
v_add_u32 v5, s20, v5
v_mul_u32_u24 v5, 1152, v5
v_lshlrev_b32 v6, 4, v3
v_add_u32 v5, v5, v6
s_mov_b32 s26, 0x00ff00ff
s_mov_b32 s27, 0x00ff00ff
s_mov_b32 s21, 0
buffer_load_dwordx4 v[60:63], v5, s[92:95], s21 offen offset:0 nt
buffer_load_dwordx4 v[64:67], v5, s[92:95], s21 offen offset:256 nt
buffer_load_dwordx4 v[68:71], v5, s[92:95], s21 offen offset:512 nt
buffer_load_dwordx4 v[72:75], v5, s[92:95], s21 offen offset:768 nt
s_mov_b64 exec, s[26:27]
buffer_load_dwordx4 v[76:79], v5, s[92:95], s21 offen offset:1024 nt
s_mov_b64 exec, -1
s_add_u32 s21, s21, 1152
buffer_load_dwordx4 v[80:83], v5, s[92:95], s21 offen offset:0 nt
buffer_load_dwordx4 v[84:87], v5, s[92:95], s21 offen offset:256 nt
buffer_load_dwordx4 v[88:91], v5, s[92:95], s21 offen offset:512 nt
buffer_load_dwordx4 v[92:95], v5, s[92:95], s21 offen offset:768 nt
s_mov_b64 exec, s[26:27]
buffer_load_dwordx4 v[96:99], v5, s[92:95], s21 offen offset:1024 nt
s_mov_b64 exec, -1
s_add_u32 s21, s21, 1152
buffer_load_dwordx4 v[100:103], v5, s[92:95], s21 offen offset:0 nt
buffer_load_dwordx4 v[104:107], v5, s[92:95], s21 offen offset:256 nt
buffer_load_dwordx4 v[108:111], v5, s[92:95], s21 offen offset:512 nt
buffer_load_dwordx4 v[112:115], v5, s[92:95], s21 offen offset:768 nt
s_mov_b64 exec, s[26:27]
buffer_load_dwordx4 v[116:119], v5, s[92:95], s21 offen offset:1024 nt
s_mov_b64 exec, -1
s_add_u32 s21, s21, 1152
buffer_load_dwordx4 v[120:123], v5, s[92:95], s21 offen offset:0 nt
buffer_load_dwordx4 v[124:127], v5, s[92:95], s21 offen offset:256 nt
buffer_load_dwordx4 v[128:131], v5, s[92:95], s21 offen offset:512 nt
buffer_load_dwordx4 v[132:135], v5, s[92:95], s21 offen offset:768 nt
s_mov_b64 exec, s[26:27]
buffer_load_dwordx4 v[136:139], v5, s[92:95], s21 offen offset:1024 nt
s_mov_b64 exec, -1
s_add_u32 s21, s21, 1152
buffer_load_dwordx4 v[140:143], v5, s[92:95], s21 offen offset:0 nt
buffer_load_dwordx4 v[144:147], v5, s[92:95], s21 offen offset:256 nt
buffer_load_dwordx4 v[148:151], v5, s[92:95], s21 offen offset:512 nt
buffer_load_dwordx4 v[152:155], v5, s[92:95], s21 offen offset:768 nt
s_mov_b64 exec, s[26:27]
buffer_load_dwordx4 v[156:159], v5, s[92:95], s21 offen offset:1024 nt
s_mov_b64 exec, -1
s_add_u32 s21, s21, 1152
buffer_load_dwordx4 v[160:163], v5, s[92:95], s21 offen offset:0 nt
buffer_load_dwordx4 v[164:167], v5, s[92:95], s21 offen offset:256 nt
buffer_load_dwordx4 v[168:171], v5, s[92:95], s21 offen offset:512 nt
buffer_load_dwordx4 v[172:175], v5, s[92:95], s21 offen offset:768 nt
s_mov_b64 exec, s[26:27]
buffer_load_dwordx4 v[176:179], v5, s[92:95], s21 offen offset:1024 nt
s_mov_b64 exec, -1
s_add_u32 s21, s21, 1152
buffer_load_dwordx4 v[180:183], v5, s[92:95], s21 offen offset:0 nt
buffer_load_dwordx4 v[184:187], v5, s[92:95], s21 offen offset:256 nt
buffer_load_dwordx4 v[188:191], v5, s[92:95], s21 offen offset:512 nt
buffer_load_dwordx4 v[192:195], v5, s[92:95], s21 offen offset:768 nt
s_mov_b64 exec, s[26:27]
buffer_load_dwordx4 v[196:199], v5, s[92:95], s21 offen offset:1024 nt
s_mov_b64 exec, -1
s_add_u32 s21, s21, 1152
buffer_load_dwordx4 v[200:203], v5, s[92:95], s21 offen offset:0 nt
buffer_load_dwordx4 v[204:207], v5, s[92:95], s21 offen offset:256 nt
buffer_load_dwordx4 v[208:211], v5, s[92:95], s21 offen offset:512 nt
buffer_load_dwordx4 v[212:215], v5, s[92:95], s21 offen offset:768 nt
s_mov_b64 exec, s[26:27]
buffer_load_dwordx4 v[216:219], v5, s[92:95], s21 offen offset:1024 nt
s_mov_b64 exec, -1
s_add_u32 s21, s21, 1152
buffer_load_dwordx4 v[220:223], v5, s[92:95], s21 offen offset:0 nt
buffer_load_dwordx4 v[224:227], v5, s[92:95], s21 offen offset:256 nt
buffer_load_dwordx4 v[228:231], v5, s[92:95], s21 offen offset:512 nt
buffer_load_dwordx4 v[232:235], v5, s[92:95], s21 offen offset:768 nt
s_mov_b64 exec, s[26:27]
buffer_load_dwordx4 v[236:239], v5, s[92:95], s21 offen offset:1024 nt
s_mov_b64 exec, -1
s_add_u32 s21, s21, 1152
s_mov_b32 s24, 200000
L_lwait0:
ds_read_b32 v9, v8 offset:7680
s_waitcnt lgkmcnt(0)
v_readfirstlane_b32 s20, v9
s_sub_u32 s24, s24, 1
s_cmp_eq_u32 s24, 0
s_cbranch_scc1 L_ldone0
s_cmp_lt_u32 s20, 4
s_cbranch_scc1 L_lwait0
L_ldone0:
v_lshrrev_b32 v8, 3, v3
v_mul_u32_u24 v8, 576, v8
v_mul_u32_u24 v9, 36, v4
v_add_u32 v8, v8, v9
s_mul_i32 s20, s19, 144
v_add_u32 v8, s20, v8
ds_read_b32 v32, v8 offset:5376
ds_read_b32 v42, v8 offset:6528
ds_read_b32 v33, v8 offset:5380
ds_read_b32 v43, v8 offset:6532
ds_read_b32 v34, v8 offset:5384
ds_read_b32 v44, v8 offset:6536
ds_read_b32 v35, v8 offset:5388
ds_read_b32 v45, v8 offset:6540
ds_read_b32 v36, v8 offset:5392
ds_read_b32 v46, v8 offset:6544
ds_read_b32 v37, v8 offset:5396
ds_read_b32 v47, v8 offset:6548
ds_read_b32 v38, v8 offset:5400
ds_read_b32 v48, v8 offset:6552
ds_read_b32 v39, v8 offset:5404
ds_read_b32 v49, v8 offset:6556
ds_read_b32 v40, v8 offset:5408
ds_read_b32 v50, v8 offset:6560
s_mov_b32 s20, 0x3d372713
s_mov_b32 s21, 0xc0135761
s_waitcnt lgkmcnt(0)
v_mul_f32 v28, v32, v32
v_fma_f32 v28, v28, s20, 1.0
v_mul_f32 v28, v28, v32
v_mul_f32 v28, s21, v28
v_exp_f32 v28, v28
s_nop 0
v_add_f32 v28, 1.0, v28
v_rcp_f32 v28, v28
s_nop 0
v_mul_f32 v28, v28, v32
v_mul_f32 v32, v28, v42
v_mul_f32 v28, v33, v33
v_fma_f32 v28, v28, s20, 1.0
v_mul_f32 v28, v28, v33
v_mul_f32 v28, s21, v28
v_exp_f32 v28, v28
s_nop 0
v_add_f32 v28, 1.0, v28
v_rcp_f32 v28, v28
s_nop 0
v_mul_f32 v28, v28, v33
v_mul_f32 v33, v28, v43
v_mul_f32 v28, v34, v34
v_fma_f32 v28, v28, s20, 1.0
v_mul_f32 v28, v28, v34
v_mul_f32 v28, s21, v28
v_exp_f32 v28, v28
s_nop 0
v_add_f32 v28, 1.0, v28
v_rcp_f32 v28, v28
s_nop 0
v_mul_f32 v28, v28, v34
v_mul_f32 v34, v28, v44
v_mul_f32 v28, v35, v35
v_fma_f32 v28, v28, s20, 1.0
v_mul_f32 v28, v28, v35
v_mul_f32 v28, s21, v28
v_exp_f32 v28, v28
s_nop 0
v_add_f32 v28, 1.0, v28
v_rcp_f32 v28, v28
s_nop 0
v_mul_f32 v28, v28, v35
v_mul_f32 v35, v28, v45
v_mul_f32 v28, v36, v36
v_fma_f32 v28, v28, s20, 1.0
v_mul_f32 v28, v28, v36
v_mul_f32 v28, s21, v28
v_exp_f32 v28, v28
s_nop 0
v_add_f32 v28, 1.0, v28
v_rcp_f32 v28, v28
s_nop 0
v_mul_f32 v28, v28, v36
v_mul_f32 v36, v28, v46
v_mul_f32 v28, v37, v37
v_fma_f32 v28, v28, s20, 1.0
v_mul_f32 v28, v28, v37
v_mul_f32 v28, s21, v28
v_exp_f32 v28, v28
s_nop 0
v_add_f32 v28, 1.0, v28
v_rcp_f32 v28, v28
s_nop 0
v_mul_f32 v28, v28, v37
v_mul_f32 v37, v28, v47
v_mul_f32 v28, v38, v38
v_fma_f32 v28, v28, s20, 1.0
v_mul_f32 v28, v28, v38
v_mul_f32 v28, s21, v28
v_exp_f32 v28, v28
s_nop 0
v_add_f32 v28, 1.0, v28
v_rcp_f32 v28, v28
s_nop 0
v_mul_f32 v28, v28, v38
v_mul_f32 v38, v28, v48
v_mul_f32 v28, v39, v39
v_fma_f32 v28, v28, s20, 1.0
v_mul_f32 v28, v28, v39
v_mul_f32 v28, s21, v28
v_exp_f32 v28, v28
s_nop 0
v_add_f32 v28, 1.0, v28
v_rcp_f32 v28, v28
s_nop 0
v_mul_f32 v28, v28, v39
v_mul_f32 v39, v28, v49
v_mul_f32 v28, v40, v40
v_fma_f32 v28, v28, s20, 1.0
v_mul_f32 v28, v28, v40
v_mul_f32 v28, s21, v28
v_exp_f32 v28, v28
s_nop 0
v_add_f32 v28, 1.0, v28
v_rcp_f32 v28, v28
s_nop 0
v_mul_f32 v28, v28, v40
v_mul_f32 v40, v28, v50
v_mov_b32 v41, 0
v_cvt_pk_bf16_f32 v52, v32, v33
v_cvt_pk_bf16_f32 v53, v34, v35
v_cvt_pk_bf16_f32 v54, v36, v37
v_cvt_pk_bf16_f32 v55, v38, v39
v_cvt_pk_bf16_f32 v56, v40, v41
v_mov_b32 v32, 0
v_mov_b32 v33, 0
v_mov_b32 v34, 0
v_mov_b32 v35, 0
v_mov_b32 v36, 0
v_mov_b32 v37, 0
v_mov_b32 v38, 0
v_mov_b32 v39, 0
v_mov_b32 v40, 0
v_mov_b32 v41, 0
v_mov_b32 v42, 0
v_mov_b32 v43, 0
v_mov_b32 v44, 0
v_mov_b32 v45, 0
v_mov_b32 v46, 0
v_mov_b32 v47, 0
v_mov_b32 v48, 0
v_mov_b32 v49, 0
v_mov_b32 v50, 0
v_mov_b32 v51, 0
s_waitcnt vmcnt(40)
v_perm_b32 v8, v52, v52, v16
v_perm_b32 v9, v52, v52, v17
v_perm_b32 v10, v52, v52, v18
v_perm_b32 v11, v52, v52, v19
s_nop 1
v_mfma_f32_16x16x32_bf16 v[32:35], v[60:63], v[8:11], v[32:35]
v_mfma_f32_16x16x32_bf16 v[36:39], v[64:67], v[8:11], v[36:39]
v_mfma_f32_16x16x32_bf16 v[40:43], v[68:71], v[8:11], v[40:43]
v_mfma_f32_16x16x32_bf16 v[44:47], v[72:75], v[8:11], v[44:47]
v_mfma_f32_16x16x32_bf16 v[48:51], v[76:79], v[8:11], v[48:51]
s_waitcnt vmcnt(35)
v_perm_b32 v12, v52, v52, v20
v_perm_b32 v13, v52, v52, v21
v_perm_b32 v14, v52, v52, v22
v_perm_b32 v15, v52, v52, v23
s_nop 1
v_mfma_f32_16x16x32_bf16 v[32:35], v[80:83], v[12:15], v[32:35]
v_mfma_f32_16x16x32_bf16 v[36:39], v[84:87], v[12:15], v[36:39]
v_mfma_f32_16x16x32_bf16 v[40:43], v[88:91], v[12:15], v[40:43]
v_mfma_f32_16x16x32_bf16 v[44:47], v[92:95], v[12:15], v[44:47]
v_mfma_f32_16x16x32_bf16 v[48:51], v[96:99], v[12:15], v[48:51]
s_waitcnt vmcnt(30)
v_perm_b32 v8, v53, v53, v16
v_perm_b32 v9, v53, v53, v17
v_perm_b32 v10, v53, v53, v18
v_perm_b32 v11, v53, v53, v19
s_nop 1
v_mfma_f32_16x16x32_bf16 v[32:35], v[100:103], v[8:11], v[32:35]
v_mfma_f32_16x16x32_bf16 v[36:39], v[104:107], v[8:11], v[36:39]
v_mfma_f32_16x16x32_bf16 v[40:43], v[108:111], v[8:11], v[40:43]
v_mfma_f32_16x16x32_bf16 v[44:47], v[112:115], v[8:11], v[44:47]
v_mfma_f32_16x16x32_bf16 v[48:51], v[116:119], v[8:11], v[48:51]
s_waitcnt vmcnt(25)
v_perm_b32 v12, v53, v53, v20
v_perm_b32 v13, v53, v53, v21
v_perm_b32 v14, v53, v53, v22
v_perm_b32 v15, v53, v53, v23
s_nop 1
v_mfma_f32_16x16x32_bf16 v[32:35], v[120:123], v[12:15], v[32:35]
v_mfma_f32_16x16x32_bf16 v[36:39], v[124:127], v[12:15], v[36:39]
v_mfma_f32_16x16x32_bf16 v[40:43], v[128:131], v[12:15], v[40:43]
v_mfma_f32_16x16x32_bf16 v[44:47], v[132:135], v[12:15], v[44:47]
v_mfma_f32_16x16x32_bf16 v[48:51], v[136:139], v[12:15], v[48:51]
s_waitcnt vmcnt(20)
v_perm_b32 v8, v54, v54, v16
v_perm_b32 v9, v54, v54, v17
v_perm_b32 v10, v54, v54, v18
v_perm_b32 v11, v54, v54, v19
s_nop 1
v_mfma_f32_16x16x32_bf16 v[32:35], v[140:143], v[8:11], v[32:35]
v_mfma_f32_16x16x32_bf16 v[36:39], v[144:147], v[8:11], v[36:39]
v_mfma_f32_16x16x32_bf16 v[40:43], v[148:151], v[8:11], v[40:43]
v_mfma_f32_16x16x32_bf16 v[44:47], v[152:155], v[8:11], v[44:47]
v_mfma_f32_16x16x32_bf16 v[48:51], v[156:159], v[8:11], v[48:51]
s_waitcnt vmcnt(15)
v_perm_b32 v12, v54, v54, v20
v_perm_b32 v13, v54, v54, v21
v_perm_b32 v14, v54, v54, v22
v_perm_b32 v15, v54, v54, v23
s_nop 1
v_mfma_f32_16x16x32_bf16 v[32:35], v[160:163], v[12:15], v[32:35]
v_mfma_f32_16x16x32_bf16 v[36:39], v[164:167], v[12:15], v[36:39]
v_mfma_f32_16x16x32_bf16 v[40:43], v[168:171], v[12:15], v[40:43]
v_mfma_f32_16x16x32_bf16 v[44:47], v[172:175], v[12:15], v[44:47]
v_mfma_f32_16x16x32_bf16 v[48:51], v[176:179], v[12:15], v[48:51]
s_waitcnt vmcnt(10)
v_perm_b32 v8, v55, v55, v16
v_perm_b32 v9, v55, v55, v17
v_perm_b32 v10, v55, v55, v18
v_perm_b32 v11, v55, v55, v19
s_nop 1
v_mfma_f32_16x16x32_bf16 v[32:35], v[180:183], v[8:11], v[32:35]
v_mfma_f32_16x16x32_bf16 v[36:39], v[184:187], v[8:11], v[36:39]
v_mfma_f32_16x16x32_bf16 v[40:43], v[188:191], v[8:11], v[40:43]
v_mfma_f32_16x16x32_bf16 v[44:47], v[192:195], v[8:11], v[44:47]
v_mfma_f32_16x16x32_bf16 v[48:51], v[196:199], v[8:11], v[48:51]
s_waitcnt vmcnt(5)
v_perm_b32 v12, v55, v55, v20
v_perm_b32 v13, v55, v55, v21
v_perm_b32 v14, v55, v55, v22
v_perm_b32 v15, v55, v55, v23
s_nop 1
v_mfma_f32_16x16x32_bf16 v[32:35], v[200:203], v[12:15], v[32:35]
v_mfma_f32_16x16x32_bf16 v[36:39], v[204:207], v[12:15], v[36:39]
v_mfma_f32_16x16x32_bf16 v[40:43], v[208:211], v[12:15], v[40:43]
v_mfma_f32_16x16x32_bf16 v[44:47], v[212:215], v[12:15], v[44:47]
v_mfma_f32_16x16x32_bf16 v[48:51], v[216:219], v[12:15], v[48:51]
s_waitcnt vmcnt(0)
v_perm_b32 v8, v56, v56, v16
v_perm_b32 v9, v56, v56, v17
v_perm_b32 v10, v56, v56, v18
v_perm_b32 v11, v56, v56, v19
s_nop 1
v_mfma_f32_16x16x32_bf16 v[32:35], v[220:223], v[8:11], v[32:35]
v_mfma_f32_16x16x32_bf16 v[36:39], v[224:227], v[8:11], v[36:39]
v_mfma_f32_16x16x32_bf16 v[40:43], v[228:231], v[8:11], v[40:43]
v_mfma_f32_16x16x32_bf16 v[44:47], v[232:235], v[8:11], v[44:47]
v_mfma_f32_16x16x32_bf16 v[48:51], v[236:239], v[8:11], v[48:51]
v_lshlrev_b32 v8, 4, v1
s_mul_i32 s20, s19, 5120
v_add_u32 v9, s20, v8
s_nop 5
ds_write_b128 v9, v[32:35] offset:8192
ds_write_b128 v9, v[36:39] offset:9216
ds_write_b128 v9, v[40:43] offset:10240
ds_write_b128 v9, v[44:47] offset:11264
ds_write_b128 v9, v[48:51] offset:12288
s_waitcnt lgkmcnt(0)
v_mov_b32 v10, 0
v_mov_b32 v11, 1
s_mov_b64 exec, 1
ds_add_u32 v10, v11 offset:7680
s_mov_b64 exec, -1
s_mov_b32 s23, 200000
L_lwait:
ds_read_b32 v11, v10 offset:7680
s_waitcnt lgkmcnt(0)
v_readfirstlane_b32 s20, v11
s_sub_u32 s23, s23, 1
s_cmp_eq_u32 s23, 0
s_cbranch_scc1 L_ldone
s_cmp_lt_u32 s20, 8
s_cbranch_scc1 L_lwait
L_ldone:
s_lshl_b32 s20, s19, 10
v_add_u32 v9, s20, v8
ds_read_b128 v[32:35], v9 offset:8192
ds_read_b128 v[36:39], v9 offset:13312
ds_read_b128 v[40:43], v9 offset:18432
ds_read_b128 v[44:47], v9 offset:23552
ds_read_b128 v[64:67], v8 offset:12288
ds_read_b128 v[68:71], v8 offset:17408
ds_read_b128 v[72:75], v8 offset:22528
ds_read_b128 v[76:79], v8 offset:27648
v_lshrrev_b32 v8, 3, v3
v_mul_u32_u24 v8, 4608, v8
v_lshlrev_b32 v9, 7, v4
v_add_u32 v8, v8, v9
v_and_b32 v9, 7, v1
v_lshlrev_b32 v9, 4, v9
v_add_u32 v8, v8, v9
s_mul_i32 s21, s15, 9216
s_add_u32 s21, s21, 4194304
s_add_u32 s22, s21, s20
s_add_u32 s21, s21, 4096
s_waitcnt lgkmcnt(0)
v_add_f32 v32, v32, v36
v_add_f32 v40, v40, v44
v_add_f32 v32, v32, v40
v_add_f32 v33, v33, v37
v_add_f32 v41, v41, v45
v_add_f32 v33, v33, v41
v_add_f32 v34, v34, v38
v_add_f32 v42, v42, v46
v_add_f32 v34, v34, v42
v_add_f32 v35, v35, v39
v_add_f32 v43, v43, v47
v_add_f32 v35, v35, v43
v_add_f32 v64, v64, v68
v_add_f32 v72, v72, v76
v_add_f32 v64, v64, v72
v_add_f32 v65, v65, v69
v_add_f32 v73, v73, v77
v_add_f32 v65, v65, v73
v_add_f32 v66, v66, v70
v_add_f32 v74, v74, v78
v_add_f32 v66, v66, v74
v_add_f32 v67, v67, v71
v_add_f32 v75, v75, v79
v_add_f32 v67, v67, v75
v_mov_b32 v96, v32
v_mov_b32 v97, s62
v_mov_b32 v98, v33
v_mov_b32 v99, s63
v_mov_b32 v100, v34
v_mov_b32 v101, s62
v_mov_b32 v102, v35
v_mov_b32 v103, s63
v_mov_b32 v104, v64
v_mov_b32 v105, s62
v_mov_b32 v106, v65
v_mov_b32 v107, s63
v_mov_b32 v108, v66
v_mov_b32 v109, s62
v_mov_b32 v110, v67
v_mov_b32 v111, s63
buffer_store_dwordx4 v[96:99], v8, s[72:75], s22 offen sc1
buffer_store_dwordx4 v[100:103], v8, s[72:75], s22 offen offset:512 sc1
s_cmp_lg_u32 s19, 0
s_cbranch_scc1 L_noffn
s_mov_b32 exec_hi, 0
buffer_store_dwordx4 v[104:107], v8, s[72:75], s21 offen sc1
buffer_store_dwordx4 v[108:111], v8, s[72:75], s21 offen offset:256 sc1
s_mov_b64 exec, -1
L_noffn:
s_mov_b32 s80, s44
s_mov_b32 s81, s45
s_mov_b32 s82, 4718592
s_mov_b32 s83, 0x20000
s_lshl_b32 s20, s12, 8
s_lshl_b32 s21, s14, 5
s_add_u32 s20, s20, s21
v_lshlrev_b32 v5, 3, v4
v_add_u32 v5, s20, v5
v_mul_u32_u24 v5, 1152, v5
v_lshlrev_b32 v6, 4, v3
v_add_u32 v5, v5, v6
s_lshl_b32 s21, s19, 8
s_add_u32 s23, s21, 4608
buffer_load_dwordx4 v[216:219], v5, s[80:83], s21 offen offset:0 nt
buffer_load_dwordx4 v[220:223], v5, s[80:83], s21 offen offset:1152 nt
buffer_load_dwordx4 v[224:227], v5, s[80:83], s21 offen offset:2304 nt
buffer_load_dwordx4 v[228:231], v5, s[80:83], s21 offen offset:3456 nt
buffer_load_dwordx4 v[232:235], v5, s[80:83], s23 offen offset:0 nt
buffer_load_dwordx4 v[236:239], v5, s[80:83], s23 offen offset:1152 nt
buffer_load_dwordx4 v[240:243], v5, s[80:83], s23 offen offset:2304 nt
buffer_load_dwordx4 v[244:247], v5, s[80:83], s23 offen offset:3456 nt
s_cmp_lg_u32 s19, 0
s_cbranch_scc1 L_nowo4
s_mov_b32 s21, 1024
s_mov_b32 s23, 5632
s_mov_b32 exec_lo, 0x00ff00ff
s_mov_b32 exec_hi, 0x00ff00ff
buffer_load_dwordx4 v[184:187], v5, s[80:83], s21 offen offset:0 nt
buffer_load_dwordx4 v[188:191], v5, s[80:83], s21 offen offset:1152 nt
buffer_load_dwordx4 v[192:195], v5, s[80:83], s21 offen offset:2304 nt
buffer_load_dwordx4 v[196:199], v5, s[80:83], s21 offen offset:3456 nt
buffer_load_dwordx4 v[200:203], v5, s[80:83], s23 offen offset:0 nt
buffer_load_dwordx4 v[204:207], v5, s[80:83], s23 offen offset:1152 nt
buffer_load_dwordx4 v[208:211], v5, s[80:83], s23 offen offset:2304 nt
buffer_load_dwordx4 v[212:215], v5, s[80:83], s23 offen offset:3456 nt
s_mov_b64 exec, -1
L_nowo4:
s_cmp_lg_u32 s19, 1
s_cbranch_scc1 L_nored1
s_cmp_ge_u32 s2, 72
s_cbranch_scc1 L_nored1
s_cmp_ge_u32 s2, 36
s_cselect_b32 s25, 1, 0
s_mul_i32 s20, s25, 36
s_sub_u32 s26, s2, s20
s_mul_i32 s20, s25, 1152
s_add_u32 s84, s36, s20
s_addc_u32 s85, s37, 0
s_mov_b32 s86, 1152
s_mov_b32 s87, 0x20000
s_mov_b32 s88, s54
s_mov_b32 s89, s55
s_mov_b32 s90, 1152
s_mov_b32 s91, 0x20000
v_lshlrev_b32 v8, 2, v1
buffer_load_dword v32, v8, s[84:87], 0 offen offset:0
buffer_load_dword v40, v8, s[88:91], 0 offen offset:0
buffer_load_dword v33, v8, s[84:87], 0 offen offset:256
buffer_load_dword v41, v8, s[88:91], 0 offen offset:256
buffer_load_dword v34, v8, s[84:87], 0 offen offset:512
buffer_load_dword v42, v8, s[88:91], 0 offen offset:512
buffer_load_dword v35, v8, s[84:87], 0 offen offset:768
buffer_load_dword v43, v8, s[88:91], 0 offen offset:768
buffer_load_dword v36, v8, s[84:87], 0 offen offset:1024
buffer_load_dword v44, v8, s[88:91], 0 offen offset:1024
v_mov_b32 v9, 0
s_waitcnt vmcnt(0)
v_lshlrev_b32 v10, 16, v32
v_lshlrev_b32 v12, 16, v40
v_fmac_f32 v9, v10, v12
v_and_b32 v10, 0xffff0000, v32
v_and_b32 v12, 0xffff0000, v40
v_fmac_f32 v9, v10, v12
v_lshlrev_b32 v10, 16, v33
v_lshlrev_b32 v12, 16, v41
v_fmac_f32 v9, v10, v12
v_and_b32 v10, 0xffff0000, v33
v_and_b32 v12, 0xffff0000, v41
v_fmac_f32 v9, v10, v12
v_lshlrev_b32 v10, 16, v34
v_lshlrev_b32 v12, 16, v42
v_fmac_f32 v9, v10, v12
v_and_b32 v10, 0xffff0000, v34
v_and_b32 v12, 0xffff0000, v42
v_fmac_f32 v9, v10, v12
v_lshlrev_b32 v10, 16, v35
v_lshlrev_b32 v12, 16, v43
v_fmac_f32 v9, v10, v12
v_and_b32 v10, 0xffff0000, v35
v_and_b32 v12, 0xffff0000, v43
v_fmac_f32 v9, v10, v12
v_lshlrev_b32 v10, 16, v36
v_lshlrev_b32 v12, 16, v44
v_fmac_f32 v9, v10, v12
v_and_b32 v10, 0xffff0000, v36
v_and_b32 v12, 0xffff0000, v44
v_fmac_f32 v9, v10, v12
s_nop 1
v_add_f32_dpp v9, v9, v9 quad_perm:[1,0,3,2] row_mask:0xf bank_mask:0xf
s_nop 1
v_add_f32_dpp v9, v9, v9 quad_perm:[2,3,0,1] row_mask:0xf bank_mask:0xf
s_nop 1
v_add_f32_dpp v9, v9, v9 row_ror:4 row_mask:0xf bank_mask:0xf
s_nop 1
v_add_f32_dpp v9, v9, v9 row_ror:8 row_mask:0xf bank_mask:0xf
v_mov_b32 v10, v9
s_nop 1
v_permlane16_swap_b32 v9, v10
v_add_f32 v9, v9, v10
v_mov_b32 v10, v9
s_nop 1
v_permlane32_swap_b32 v9, v10
v_add_f32 v9, v9, v10
v_mul_f32 v9, 0xbfb8aa3b, v9
v_exp_f32 v9, v9
s_nop 0
v_add_f32 v9, 1.0, v9
v_rcp_f32 v72, v9
L_nored1:
s_waitcnt vmcnt(0)
s_barrier
s_mov_b32 s34, 0x3fb8aa3b
s_cmp_eq_u32 s19, 0
s_cbranch_scc1 L_comb
s_cmp_lg_u32 s19, 1
s_cbranch_scc1 L_nocomb
s_cmp_ge_u32 s2, 72
s_cbranch_scc1 L_nocomb
v_lshrrev_b32 v8, 2, v1
v_mul_u32_u24 v8, 9216, v8
v_and_b32 v9, 3, v1
v_lshlrev_b32 v9, 4, v9
v_add_u32 v8, v8, v9
s_mul_i32 s20, s25, 4608
s_lshr_b32 s21, s26, 3
s_lshl_b32 s21, s21, 10
s_and_b32 s3, s26, 7
s_lshl_b32 s3, s3, 6
s_add_u32 s21, s21, s3
s_mov_b32 s3, 256
s_cmp_lt_u32 s26, 32
s_cselect_b32 s3, 512, s3
s_add_u32 s20, s20, s21
s_add_u32 s20, s20, 4194304
s_mov_b32 s24, 200000
L_fpoll:
s_mov_b32 s21, s20
buffer_load_dwordx4 v[80:83], v8, s[72:75], s21 offen sc1
s_add_u32 s27, s21, s3
buffer_load_dwordx4 v[84:87], v8, s[72:75], s27 offen sc1
s_add_u32 s21, s21, 147456
buffer_load_dwordx4 v[88:91], v8, s[72:75], s21 offen sc1
s_add_u32 s27, s21, s3
buffer_load_dwordx4 v[92:95], v8, s[72:75], s27 offen sc1
s_waitcnt vmcnt(0)
v_mov_b32 v9, 0
v_xor_b32 v10, s62, v81
v_xor_b32 v13, s63, v83
v_or3_b32 v9, v9, v10, v13
v_xor_b32 v10, s62, v85
v_xor_b32 v13, s63, v87
v_or3_b32 v9, v9, v10, v13
v_xor_b32 v10, s62, v89
v_xor_b32 v13, s63, v91
v_or3_b32 v9, v9, v10, v13
v_xor_b32 v10, s62, v93
v_xor_b32 v13, s63, v95
v_or3_b32 v9, v9, v10, v13
v_cmp_ne_u32 vcc, 0, v9
s_sub_u32 s24, s24, 1
s_cmp_eq_u32 s24, 0
s_cbranch_scc1 L_fdone
s_cbranch_vccz L_fdone
s_sleep 16
s_branch L_fpoll
L_fdone:
v_sub_f32 v9, 1.0, v72
v_add_f32 v80, v80, v88
v_add_f32 v82, v82, v90
v_add_f32 v84, v84, v92
v_add_f32 v86, v86, v94
v_mul_f32 v68, v80, v9
v_mul_f32 v69, v82, v9
v_mul_f32 v70, v84, v9
v_mul_f32 v71, v86, v9
s_branch L_nocomb
L_comb:
v_lshlrev_b32 v8, 4, v1
ds_read_b128 v[32:35], v8 offset:1024
ds_read_b128 v[36:39], v8 offset:2048
ds_read_b128 v[40:43], v8 offset:3072
ds_read_b128 v[44:47], v8 offset:4096
v_lshrrev_b32 v9, 5, v1
v_lshlrev_b32 v9, 3, v9
ds_read_b64 v[48:49], v9 offset:5120
ds_read_b64 v[50:51], v9 offset:5136
ds_read_b64 v[52:53], v9 offset:5152
ds_read_b64 v[54:55], v9 offset:5168
v_and_b32 v60, 7, v1
v_mul_u32_u24 v60, 4096, v60
v_mov_b32 v61, v60
v_lshlrev_b32 v62, 5, v4
v_add_u32 v60, v60, v62
v_bfe_u32 v62, v1, 3, 1
v_lshlrev_b32 v62, 4, v62
v_add_u32 v60, v60, v62
s_mul_i32 s21, s15, 32768
s_add_u32 s21, s21, 1048576
s_lshl_b32 s20, s14, 7
s_add_u32 s23, s21, s20
s_lshr_b32 s20, s14, 2
s_lshl_b32 s20, s20, 4
s_add_u32 s22, s21, s20
s_waitcnt lgkmcnt(0)
v_max3_f32 v56, v48, v50, v52
v_max_f32 v56, v56, v54
v_sub_f32 v48, v48, v56
v_mul_f32 v48, s34, v48
v_exp_f32 v48, v48
v_sub_f32 v50, v50, v56
v_mul_f32 v50, s34, v50
v_exp_f32 v50, v50
v_sub_f32 v52, v52, v56
v_mul_f32 v52, s34, v52
v_exp_f32 v52, v52
v_sub_f32 v54, v54, v56
v_mul_f32 v54, s34, v54
v_exp_f32 v54, v54
s_nop 0
v_mul_f32 v58, v48, v49
v_fmac_f32 v58, v50, v51
v_fmac_f32 v58, v52, v53
v_fmac_f32 v58, v54, v55
v_mul_f32 v32, v32, v48
v_mul_f32 v33, v33, v48
v_mul_f32 v34, v34, v48
v_mul_f32 v35, v35, v48
v_fmac_f32 v32, v36, v50
v_fmac_f32 v33, v37, v50
v_fmac_f32 v34, v38, v50
v_fmac_f32 v35, v39, v50
v_fmac_f32 v32, v40, v52
v_fmac_f32 v33, v41, v52
v_fmac_f32 v34, v42, v52
v_fmac_f32 v35, v43, v52
v_fmac_f32 v32, v44, v54
v_fmac_f32 v33, v45, v54
v_fmac_f32 v34, v46, v54
v_fmac_f32 v35, v47, v54
v_mov_b32 v36, v32
v_mov_b32 v37, s62
v_mov_b32 v38, v33
v_mov_b32 v39, s63
v_mov_b32 v40, v34
v_mov_b32 v41, s62
v_mov_b32 v42, v35
v_mov_b32 v43, s63
v_mov_b32 v57, s62
v_mov_b32 v59, s63
s_mul_i32 s21, s2, 4096
s_add_u32 s21, s21, 1048576
v_lshlrev_b32 v8, 4, v1
v_lshlrev_b32 v9, 1, v9
buffer_store_dwordx4 v[36:39], v8, s[72:75], s21 offen sc1
buffer_store_dwordx4 v[40:43], v8, s[72:75], s21 offen offset:1024 sc1
s_mov_b32 exec_lo, 1
s_mov_b32 exec_hi, 1
buffer_store_dwordx4 v[56:59], v9, s[72:75], s21 offen offset:2048 sc1
s_mov_b64 exec, -1
s_mov_b32 s24, 200000
L_ppoll:
buffer_load_dwordx4 v[32:35], v60, s[72:75], s23 offen sc1
buffer_load_dwordx4 v[36:39], v60, s[72:75], s23 offen offset:1024 sc1
buffer_load_dwordx4 v[40:43], v61, s[72:75], s22 offen offset:2048 sc1
s_waitcnt vmcnt(0)
v_mov_b32 v9, 0
v_xor_b32 v10, s62, v33
v_xor_b32 v13, s63, v35
v_or3_b32 v9, v9, v10, v13
v_xor_b32 v10, s62, v37
v_xor_b32 v13, s63, v39
v_or3_b32 v9, v9, v10, v13
v_xor_b32 v10, s62, v41
v_xor_b32 v13, s63, v43
v_or3_b32 v9, v9, v10, v13
v_cmp_ne_u32 vcc, 0, v9
s_sub_u32 s24, s24, 1
s_cmp_eq_u32 s24, 0
s_cbranch_scc1 L_pdone
s_cbranch_vccnz L_ppoll
L_pdone:
v_mov_b32 v44, v40
s_nop 1
v_max_f32_dpp v44, v44, v44 quad_perm:[1,0,3,2] row_mask:0xf bank_mask:0xf
s_nop 1
v_max_f32_dpp v44, v44, v44 quad_perm:[2,3,0,1] row_mask:0xf bank_mask:0xf
s_nop 1
v_max_f32_dpp v44, v44, v44 row_half_mirror row_mask:0xf bank_mask:0xf
v_sub_f32 v40, v40, v44
v_mul_f32 v40, s34, v40
v_exp_f32 v40, v40
s_nop 0
v_mul_f32 v42, v42, v40
v_mul_f32 v32, v32, v40
v_mul_f32 v34, v34, v40
v_mul_f32 v36, v36, v40
v_mul_f32 v38, v38, v40
v_add_f32_dpp v32, v32, v32 quad_perm:[1,0,3,2] row_mask:0xf bank_mask:0xf
v_add_f32_dpp v34, v34, v34 quad_perm:[1,0,3,2] row_mask:0xf bank_mask:0xf
v_add_f32_dpp v36, v36, v36 quad_perm:[1,0,3,2] row_mask:0xf bank_mask:0xf
v_add_f32_dpp v38, v38, v38 quad_perm:[1,0,3,2] row_mask:0xf bank_mask:0xf
v_add_f32_dpp v42, v42, v42 quad_perm:[1,0,3,2] row_mask:0xf bank_mask:0xf
v_add_f32_dpp v32, v32, v32 quad_perm:[2,3,0,1] row_mask:0xf bank_mask:0xf
v_add_f32_dpp v34, v34, v34 quad_perm:[2,3,0,1] row_mask:0xf bank_mask:0xf
v_add_f32_dpp v36, v36, v36 quad_perm:[2,3,0,1] row_mask:0xf bank_mask:0xf
v_add_f32_dpp v38, v38, v38 quad_perm:[2,3,0,1] row_mask:0xf bank_mask:0xf
v_add_f32_dpp v42, v42, v42 quad_perm:[2,3,0,1] row_mask:0xf bank_mask:0xf
v_add_f32_dpp v32, v32, v32 row_half_mirror row_mask:0xf bank_mask:0xf
v_add_f32_dpp v34, v34, v34 row_half_mirror row_mask:0xf bank_mask:0xf
v_add_f32_dpp v36, v36, v36 row_half_mirror row_mask:0xf bank_mask:0xf
v_add_f32_dpp v38, v38, v38 row_half_mirror row_mask:0xf bank_mask:0xf
v_add_f32_dpp v42, v42, v42 row_half_mirror row_mask:0xf bank_mask:0xf
v_rcp_f32 v42, v42
v_lshlrev_b32 v8, 4, v4
v_bfe_u32 v9, v1, 3, 1
v_lshlrev_b32 v9, 3, v9
v_add_u32 v8, v8, v9
v_mul_f32 v32, v32, v42
v_mul_f32 v34, v34, v42
v_mul_f32 v36, v36, v42
v_mul_f32 v38, v38, v42
v_cvt_pk_bf16_f32 v32, v32, v34
v_cvt_pk_bf16_f32 v33, v36, v38
ds_write_b64 v8, v[32:33] offset:7744
s_waitcnt lgkmcnt(0)
L_nocomb:
s_barrier
v_lshlrev_b32 v8, 4, v4
ds_read_b128 v[36:39], v8 offset:7744
s_mul_i32 s21, s2, 4608
s_add_u32 s21, s21, 2097152
v_lshlrev_b32 v58, 7, v4
v_and_b32 v59, 7, v1
v_lshlrev_b32 v59, 4, v59
v_add_u32 v58, v58, v59
s_lshl_b32 s20, s19, 10
s_add_u32 s23, s21, s20
s_add_u32 s21, s21, 4096
s_waitcnt vmcnt(0) lgkmcnt(0)
s_cmp_eq_u32 s19, 0
s_cbranch_scc1 L_g2
v_perm_b32 v8, v36, v36, v16
v_perm_b32 v9, v36, v36, v17
v_perm_b32 v10, v36, v36, v18
v_perm_b32 v11, v36, v36, v19
s_nop 1
v_mfma_f32_16x16x32_bf16 v[40:43], v[216:219], v[8:11], 0
v_perm_b32 v12, v36, v36, v20
v_perm_b32 v13, v36, v36, v21
v_perm_b32 v14, v36, v36, v22
v_perm_b32 v15, v36, v36, v23
s_nop 1
v_mfma_f32_16x16x32_bf16 v[40:43], v[220:223], v[12:15], v[40:43]
v_perm_b32 v8, v37, v37, v16
v_perm_b32 v9, v37, v37, v17
v_perm_b32 v10, v37, v37, v18
v_perm_b32 v11, v37, v37, v19
s_nop 1
v_mfma_f32_16x16x32_bf16 v[40:43], v[224:227], v[8:11], v[40:43]
v_perm_b32 v12, v37, v37, v20
v_perm_b32 v13, v37, v37, v21
v_perm_b32 v14, v37, v37, v22
v_perm_b32 v15, v37, v37, v23
s_nop 1
v_mfma_f32_16x16x32_bf16 v[40:43], v[228:231], v[12:15], v[40:43]
v_perm_b32 v8, v38, v38, v16
v_perm_b32 v9, v38, v38, v17
v_perm_b32 v10, v38, v38, v18
v_perm_b32 v11, v38, v38, v19
s_nop 1
v_mfma_f32_16x16x32_bf16 v[40:43], v[232:235], v[8:11], v[40:43]
v_perm_b32 v12, v38, v38, v20
v_perm_b32 v13, v38, v38, v21
v_perm_b32 v14, v38, v38, v22
v_perm_b32 v15, v38, v38, v23
s_nop 1
v_mfma_f32_16x16x32_bf16 v[40:43], v[236:239], v[12:15], v[40:43]
v_perm_b32 v8, v39, v39, v16
v_perm_b32 v9, v39, v39, v17
v_perm_b32 v10, v39, v39, v18
v_perm_b32 v11, v39, v39, v19
s_nop 1
v_mfma_f32_16x16x32_bf16 v[40:43], v[240:243], v[8:11], v[40:43]
v_perm_b32 v12, v39, v39, v20
v_perm_b32 v13, v39, v39, v21
v_perm_b32 v14, v39, v39, v22
v_perm_b32 v15, v39, v39, v23
s_nop 1
v_mfma_f32_16x16x32_bf16 v[40:43], v[244:247], v[12:15], v[40:43]
s_branch L_gdn
L_g2:
v_perm_b32 v8, v36, v36, v16
v_perm_b32 v9, v36, v36, v17
v_perm_b32 v10, v36, v36, v18
v_perm_b32 v11, v36, v36, v19
s_nop 1
v_mfma_f32_16x16x32_bf16 v[40:43], v[216:219], v[8:11], 0
v_mfma_f32_16x16x32_bf16 v[44:47], v[184:187], v[8:11], 0
v_perm_b32 v12, v36, v36, v20
v_perm_b32 v13, v36, v36, v21
v_perm_b32 v14, v36, v36, v22
v_perm_b32 v15, v36, v36, v23
s_nop 1
v_mfma_f32_16x16x32_bf16 v[40:43], v[220:223], v[12:15], v[40:43]
v_mfma_f32_16x16x32_bf16 v[44:47], v[188:191], v[12:15], v[44:47]
v_perm_b32 v8, v37, v37, v16
v_perm_b32 v9, v37, v37, v17
v_perm_b32 v10, v37, v37, v18
v_perm_b32 v11, v37, v37, v19
s_nop 1
v_mfma_f32_16x16x32_bf16 v[40:43], v[224:227], v[8:11], v[40:43]
v_mfma_f32_16x16x32_bf16 v[44:47], v[192:195], v[8:11], v[44:47]
v_perm_b32 v12, v37, v37, v20
v_perm_b32 v13, v37, v37, v21
v_perm_b32 v14, v37, v37, v22
v_perm_b32 v15, v37, v37, v23
s_nop 1
v_mfma_f32_16x16x32_bf16 v[40:43], v[228:231], v[12:15], v[40:43]
v_mfma_f32_16x16x32_bf16 v[44:47], v[196:199], v[12:15], v[44:47]
v_perm_b32 v8, v38, v38, v16
v_perm_b32 v9, v38, v38, v17
v_perm_b32 v10, v38, v38, v18
v_perm_b32 v11, v38, v38, v19
s_nop 1
v_mfma_f32_16x16x32_bf16 v[40:43], v[232:235], v[8:11], v[40:43]
v_mfma_f32_16x16x32_bf16 v[44:47], v[200:203], v[8:11], v[44:47]
v_perm_b32 v12, v38, v38, v20
v_perm_b32 v13, v38, v38, v21
v_perm_b32 v14, v38, v38, v22
v_perm_b32 v15, v38, v38, v23
s_nop 1
v_mfma_f32_16x16x32_bf16 v[40:43], v[236:239], v[12:15], v[40:43]
v_mfma_f32_16x16x32_bf16 v[44:47], v[204:207], v[12:15], v[44:47]
v_perm_b32 v8, v39, v39, v16
v_perm_b32 v9, v39, v39, v17
v_perm_b32 v10, v39, v39, v18
v_perm_b32 v11, v39, v39, v19
s_nop 1
v_mfma_f32_16x16x32_bf16 v[40:43], v[240:243], v[8:11], v[40:43]
v_mfma_f32_16x16x32_bf16 v[44:47], v[208:211], v[8:11], v[44:47]
v_perm_b32 v12, v39, v39, v20
v_perm_b32 v13, v39, v39, v21
v_perm_b32 v14, v39, v39, v22
v_perm_b32 v15, v39, v39, v23
s_nop 1
v_mfma_f32_16x16x32_bf16 v[40:43], v[244:247], v[12:15], v[40:43]
v_mfma_f32_16x16x32_bf16 v[44:47], v[212:215], v[12:15], v[44:47]
s_nop 7
v_mov_b32 v48, v44
v_mov_b32 v49, s62
v_mov_b32 v50, v45
v_mov_b32 v51, s63
v_mov_b32 v52, v46
v_mov_b32 v53, s62
v_mov_b32 v54, v47
v_mov_b32 v55, s63
s_mov_b64 exec, 0x00ff00ff
buffer_store_dwordx4 v[48:51], v58, s[72:75], s21 offen sc1
buffer_store_dwordx4 v[52:55], v58, s[72:75], s21 offen offset:256 sc1
s_mov_b64 exec, -1
L_gdn:
s_nop 7
v_mov_b32 v60, v40
v_mov_b32 v61, s62
v_mov_b32 v62, v41
v_mov_b32 v63, s63
v_mov_b32 v64, v42
v_mov_b32 v65, s62
v_mov_b32 v66, v43
v_mov_b32 v67, s63
s_mov_b32 exec_lo, 0x00ff00ff
s_mov_b32 exec_hi, 0x00ff00ff
buffer_store_dwordx4 v[60:63], v58, s[72:75], s23 offen sc1
buffer_store_dwordx4 v[64:67], v58, s[72:75], s23 offen offset:512 sc1
s_mov_b64 exec, -1
s_cmp_lg_u32 s19, 1
s_cbranch_scc1 L_fin
s_cmp_ge_u32 s2, 72
s_cbranch_scc1 L_fin
v_lshrrev_b32 v8, 2, v1
v_mul_u32_u24 v8, 4608, v8
v_and_b32 v9, 3, v1
v_lshlrev_b32 v9, 4, v9
v_add_u32 v8, v8, v9
s_mul_i32 s20, s25, 589824
s_lshr_b32 s21, s26, 3
s_lshl_b32 s21, s21, 10
s_and_b32 s3, s26, 7
s_lshl_b32 s3, s3, 6
s_add_u32 s21, s21, s3
s_mov_b32 s3, 256
s_cmp_lt_u32 s26, 32
s_cselect_b32 s3, 512, s3
s_add_u32 s20, s20, s21
s_add_u32 s20, s20, 2097152
v_mul_u32_u24 v14, 4608, v1
s_mov_b32 s22, 2686976
s_mov_b32 s23, 2981888
v_mov_b32 v145, s62
v_mov_b32 v147, s63
v_mov_b32 v149, s62
v_mov_b32 v151, s63
s_mov_b32 s24, 200000
L_ypoll:
s_mov_b32 s21, s20
buffer_load_dwordx4 v[80:83], v8, s[72:75], s21 offen sc1
s_add_u32 s27, s21, s3
buffer_load_dwordx4 v[84:87], v8, s[72:75], s27 offen sc1
s_add_u32 s21, s21, 73728
buffer_load_dwordx4 v[88:91], v8, s[72:75], s21 offen sc1
s_add_u32 s27, s21, s3
buffer_load_dwordx4 v[92:95], v8, s[72:75], s27 offen sc1
s_add_u32 s21, s21, 73728
buffer_load_dwordx4 v[96:99], v8, s[72:75], s21 offen sc1
s_add_u32 s27, s21, s3
buffer_load_dwordx4 v[100:103], v8, s[72:75], s27 offen sc1
s_add_u32 s21, s21, 73728
buffer_load_dwordx4 v[104:107], v8, s[72:75], s21 offen sc1
s_add_u32 s27, s21, s3
buffer_load_dwordx4 v[108:111], v8, s[72:75], s27 offen sc1
s_add_u32 s21, s21, 73728
buffer_load_dwordx4 v[112:115], v8, s[72:75], s21 offen sc1
s_add_u32 s27, s21, s3
buffer_load_dwordx4 v[116:119], v8, s[72:75], s27 offen sc1
s_add_u32 s21, s21, 73728
buffer_load_dwordx4 v[120:123], v8, s[72:75], s21 offen sc1
s_add_u32 s27, s21, s3
buffer_load_dwordx4 v[124:127], v8, s[72:75], s27 offen sc1
s_add_u32 s21, s21, 73728
buffer_load_dwordx4 v[128:131], v8, s[72:75], s21 offen sc1
s_add_u32 s27, s21, s3
buffer_load_dwordx4 v[132:135], v8, s[72:75], s27 offen sc1
s_add_u32 s21, s21, 73728
buffer_load_dwordx4 v[136:139], v8, s[72:75], s21 offen sc1
s_add_u32 s27, s21, s3
buffer_load_dwordx4 v[140:143], v8, s[72:75], s27 offen sc1
s_cmp_lg_u32 s2, 0
s_cbranch_scc1 L_noextra
buffer_load_dwordx4 v[144:147], v14, s[72:75], s22 offen sc1
buffer_load_dwordx4 v[148:151], v14, s[72:75], s23 offen sc1
L_noextra:
s_waitcnt vmcnt(0)
v_mov_b32 v9, 0
v_xor_b32 v10, s62, v81
v_xor_b32 v13, s63, v83
v_or3_b32 v9, v9, v10, v13
v_xor_b32 v10, s62, v85
v_xor_b32 v13, s63, v87
v_or3_b32 v9, v9, v10, v13
v_xor_b32 v10, s62, v89
v_xor_b32 v13, s63, v91
v_or3_b32 v9, v9, v10, v13
v_xor_b32 v10, s62, v93
v_xor_b32 v13, s63, v95
v_or3_b32 v9, v9, v10, v13
v_xor_b32 v10, s62, v97
v_xor_b32 v13, s63, v99
v_or3_b32 v9, v9, v10, v13
v_xor_b32 v10, s62, v101
v_xor_b32 v13, s63, v103
v_or3_b32 v9, v9, v10, v13
v_xor_b32 v10, s62, v105
v_xor_b32 v13, s63, v107
v_or3_b32 v9, v9, v10, v13
v_xor_b32 v10, s62, v109
v_xor_b32 v13, s63, v111
v_or3_b32 v9, v9, v10, v13
v_xor_b32 v10, s62, v113
v_xor_b32 v13, s63, v115
v_or3_b32 v9, v9, v10, v13
v_xor_b32 v10, s62, v117
v_xor_b32 v13, s63, v119
v_or3_b32 v9, v9, v10, v13
v_xor_b32 v10, s62, v121
v_xor_b32 v13, s63, v123
v_or3_b32 v9, v9, v10, v13
v_xor_b32 v10, s62, v125
v_xor_b32 v13, s63, v127
v_or3_b32 v9, v9, v10, v13
v_xor_b32 v10, s62, v129
v_xor_b32 v13, s63, v131
v_or3_b32 v9, v9, v10, v13
v_xor_b32 v10, s62, v133
v_xor_b32 v13, s63, v135
v_or3_b32 v9, v9, v10, v13
v_xor_b32 v10, s62, v137
v_xor_b32 v13, s63, v139
v_or3_b32 v9, v9, v10, v13
v_xor_b32 v10, s62, v141
v_xor_b32 v13, s63, v143
v_or3_b32 v9, v9, v10, v13
v_xor_b32 v10, s62, v145
v_xor_b32 v13, s63, v147
v_or3_b32 v9, v9, v10, v13
v_xor_b32 v10, s62, v149
v_xor_b32 v13, s63, v151
v_or3_b32 v9, v9, v10, v13
v_cmp_ne_u32 vcc, 0, v9
s_sub_u32 s24, s24, 1
s_cmp_eq_u32 s24, 0
s_cbranch_scc1 L_ydone
s_cbranch_vccnz L_ypoll
L_ydone:
v_add_f32 v80, v80, v88
v_add_f32 v80, v80, v96
v_add_f32 v80, v80, v104
v_add_f32 v80, v80, v112
v_add_f32 v80, v80, v120
v_add_f32 v80, v80, v128
v_add_f32 v80, v80, v136
v_add_f32 v82, v82, v90
v_add_f32 v82, v82, v98
v_add_f32 v82, v82, v106
v_add_f32 v82, v82, v114
v_add_f32 v82, v82, v122
v_add_f32 v82, v82, v130
v_add_f32 v82, v82, v138
v_add_f32 v84, v84, v92
v_add_f32 v84, v84, v100
v_add_f32 v84, v84, v108
v_add_f32 v84, v84, v116
v_add_f32 v84, v84, v124
v_add_f32 v84, v84, v132
v_add_f32 v84, v84, v140
v_add_f32 v86, v86, v94
v_add_f32 v86, v86, v102
v_add_f32 v86, v86, v110
v_add_f32 v86, v86, v118
v_add_f32 v86, v86, v126
v_add_f32 v86, v86, v134
v_add_f32 v86, v86, v142
v_fma_f32 v80, v80, v72, v68
v_fma_f32 v82, v82, v72, v69
v_fma_f32 v84, v84, v72, v70
v_fma_f32 v86, v86, v72, v71
s_nop 1
v_add_f32_dpp v80, v80, v80 row_ror:4 row_mask:0xf bank_mask:0xf
s_nop 1
v_add_f32_dpp v80, v80, v80 row_ror:8 row_mask:0xf bank_mask:0xf
v_mov_b32 v10, v80
s_nop 1
v_permlane16_swap_b32 v80, v10
v_add_f32 v80, v80, v10
v_mov_b32 v10, v80
s_nop 1
v_permlane32_swap_b32 v80, v10
v_add_f32 v80, v80, v10
s_nop 1
v_add_f32_dpp v82, v82, v82 row_ror:4 row_mask:0xf bank_mask:0xf
s_nop 1
v_add_f32_dpp v82, v82, v82 row_ror:8 row_mask:0xf bank_mask:0xf
v_mov_b32 v10, v82
s_nop 1
v_permlane16_swap_b32 v82, v10
v_add_f32 v82, v82, v10
v_mov_b32 v10, v82
s_nop 1
v_permlane32_swap_b32 v82, v10
v_add_f32 v82, v82, v10
s_nop 1
v_add_f32_dpp v84, v84, v84 row_ror:4 row_mask:0xf bank_mask:0xf
s_nop 1
v_add_f32_dpp v84, v84, v84 row_ror:8 row_mask:0xf bank_mask:0xf
v_mov_b32 v10, v84
s_nop 1
v_permlane16_swap_b32 v84, v10
v_add_f32 v84, v84, v10
v_mov_b32 v10, v84
s_nop 1
v_permlane32_swap_b32 v84, v10
v_add_f32 v84, v84, v10
s_nop 1
v_add_f32_dpp v86, v86, v86 row_ror:4 row_mask:0xf bank_mask:0xf
s_nop 1
v_add_f32_dpp v86, v86, v86 row_ror:8 row_mask:0xf bank_mask:0xf
v_mov_b32 v10, v86
s_nop 1
v_permlane16_swap_b32 v86, v10
v_add_f32 v86, v86, v10
v_mov_b32 v10, v86
s_nop 1
v_permlane32_swap_b32 v86, v10
v_add_f32 v86, v86, v10
v_and_b32 v9, 3, v1
s_lshl_b32 s20, s26, 2
v_add_u32 v9, s20, v9
v_and_b32 v10, 7, v9
v_lshrrev_b32 v9, 3, v9
v_lshlrev_b32 v9, 5, v9
v_add_u32 v9, v9, v10
v_lshlrev_b32 v9, 1, v9
s_mul_i32 s20, s25, 1152
s_mov_b32 s84, s56
s_mov_b32 s85, s57
s_mov_b32 s86, 2304
s_mov_b32 s87, 0x20000
v_cvt_pk_bf16_f32 v80, v80, v80
v_cvt_pk_bf16_f32 v82, v82, v82
v_cvt_pk_bf16_f32 v84, v84, v84
v_cvt_pk_bf16_f32 v86, v86, v86
s_mov_b64 exec, 0xf
buffer_store_short v80, v9, s[84:87], s20 offen offset:0
buffer_store_short v82, v9, s[84:87], s20 offen offset:16
buffer_store_short v84, v9, s[84:87], s20 offen offset:32
buffer_store_short v86, v9, s[84:87], s20 offen offset:48
s_mov_b64 exec, -1
s_cmp_lg_u32 s2, 0
s_cbranch_scc1 L_fin
v_mov_b32 v8, 0x0
v_mov_b32 v9, s62
s_mov_b64 exec, 1
buffer_store_dword v9, v8, s[72:75], 0 offen sc1
s_mov_b64 exec, -1
L_fin:
L_end:
s_endpgm
.section .rodata,"a"
.p2align 6
.amdhsa_kernel gated_mix__gqa_block_cached__geglu_ffn__decode_kernel
  .amdhsa_next_free_vgpr 256
  .amdhsa_next_free_sgpr 100
  .amdhsa_accum_offset 256
  .amdhsa_group_segment_fixed_size 0
  .amdhsa_kernarg_size 104
  .amdhsa_user_sgpr_count 2
  .amdhsa_user_sgpr_kernarg_segment_ptr 1
  .amdhsa_system_sgpr_workgroup_id_x 1
.end_amdhsa_kernel
```
